```python
import torch

def _softmax(x, axis=-1):
    return torch.softmax(x, dim=axis)

def _gelu(x):
    return torch.nn.functional.gelu(x, approximate='tanh')

def _silu(x):
    return torch.nn.functional.silu(x)

def _sigmoid(x):
    return torch.sigmoid(x)

def _layernorm(x, axis=-1, eps=1e-05):
    m = x.mean(dim=axis, keepdim=True)
    v = x.var(dim=axis, keepdim=True, unbiased=False)
    return (x - m) / torch.sqrt(v + eps)

def _scatter_add(tgt, idx, src, axis=0):
    return tgt.clone().index_add_(axis, idx, src)

def _segment_sum(src, seg, n):
    out = torch.zeros((n,) + src.shape[1:], dtype=src.dtype)
    return out.index_add_(0, seg, src)

def _pad(x, pw):
    flat = tuple((v for pair in reversed(pw) for v in pair))
    return torch.nn.functional.pad(x, flat)
kernel_name = 'adaLN_cond__sliding_local_dilated__dense_activation_relu__prompt'

def setup_inputs():

    _w = lambda a: (lambda t: t.to(torch.bfloat16) if t.is_floating_point() else t)(torch.as_tensor(a))

    def _A_setup():
        B, S, D = (1, 2048, 512)
        return {'x': _w((lambda *s: torch.randn(*s, dtype=torch.bfloat16) * 0.05)(B, S, D)), 'wqkv': _w((lambda *s: torch.randn(*s, dtype=torch.bfloat16) * 0.05)(D, 3 * D)), 'wo': _w((lambda *s: torch.randn(*s, dtype=torch.bfloat16) * 0.05)(D, D))}
    _A_in = _A_setup()

    def _B_setup():
        B, S, D, Dff = (1, 2048, 512, 1376)
        return {'x': _w((lambda *s: torch.randn(*s, dtype=torch.bfloat16) * 0.05)(B, S, D)), 'w1': _w((lambda *s: torch.randn(*s, dtype=torch.bfloat16) * 0.05)(D, Dff)), 'w2': _w((lambda *s: torch.randn(*s, dtype=torch.bfloat16) * 0.05)(Dff, D))}
    _B_in = _B_setup()
    return {'A_x': _A_in['x'], 'A_wqkv': _A_in['wqkv'], 'A_wo': _A_in['wo'], 'B_x': _B_in['x'], 'B_w1': _B_in['w1'], 'B_w2': _B_in['w2'], 'c': _w((lambda *s: torch.randn(*s, dtype=torch.bfloat16) * 0.1)(1, 512) * 8.0), 'w_mod': _w((lambda *s: torch.randn(*s, dtype=torch.bfloat16) * 0.1)(512, 6 * 512) * 512 ** (-0.5) * 8.0)}

def reference(A_x, A_wqkv, A_wo, B_x, B_w1, B_w2, c, w_mod):

    def _A_ref(x, wqkv, wo):
        B, S, D = x.shape
        H = 32
        Dh = D // H
        W, dil = (8, 2)
        qkv = (lambda x, *d: x.permute(*d))((x @ wqkv).reshape(B, S, 3, H, Dh), 2, 0, 3, 1, 4)
        q, k, v = (qkv[0], qkv[1], qkv[2])
        scale = Dh ** (-0.5)
        pos = torch.arange(S)
        off = torch.arange(W) * dil
        idx = pos[:, None] - off[None, :]
        mask = idx >= 0
        idx_c = torch.where(mask, idx, 0).reshape(-1)
        kg = k[:, :, idx_c, :].reshape(B, H, S, W, Dh)
        vg = v[:, :, idx_c, :].reshape(B, H, S, W, Dh)
        logits = torch.einsum('bhsd,bhswd->bhsw', q, kg) * scale
        logits = torch.where(mask[None, None, :, :], logits, -1000000000.0)
        attn = _softmax(logits, axis=-1)
        o = torch.einsum('bhsw,bhswd->bhsd', attn, vg)
        return (lambda x, *d: x.permute(*d))(o, 0, 2, 1, 3).reshape(B, S, D) @ wo

    def _B_ref(x, w1, w2):
        h = torch.einsum('bsd,df->bsf', x, w1)
        zero = torch.zeros_like(h)
        h = torch.maximum(h, zero)
        return torch.einsum('bsf,fd->bsd', h, w2)
    x = A_x
    mod = (_silu(c) @ w_mod).reshape(c.shape[0], 6, 1, -1)
    sa, ca, ga, sb, cb, gb = (mod[:, 0].clone(), mod[:, 1].clone(), mod[:, 2].clone(), mod[:, 3].clone(), mod[:, 4].clone(), mod[:, 5].clone())
    h = _layernorm(x, axis=-1) * (1 + ca) + sa
    x = x + ga * _A_ref(h, A_wqkv, A_wo)
    h = _layernorm(x, axis=-1) * (1 + cb) + sb
    x = x + gb * _B_ref(h, B_w1, B_w2)
    return x
```

```asm
; @launch grid=(256,1,1) block=(256,1,1) lds=163840
.amdgcn_target "amdgcn-amd-amdhsa--gfx950"
.text
.globl adaLN_cond__sliding_local_dilated__dense_activation_relu__prompt_kernel
.p2align 8
.type adaLN_cond__sliding_local_dilated__dense_activation_relu__prompt_kernel,@function
adaLN_cond__sliding_local_dilated__dense_activation_relu__prompt_kernel:
    s_load_dwordx4 s[28:31], s[0:1], 48
    s_getpc_b64 s[6:7]
    v_lshlrev_b32 v4, 4, v0
    s_and_b32 s55, s2, 56
    v_lshl_add_u32 v5, s55, 9, v4
    global_load_dword a247, v5, s[6:7]
    s_load_dwordx2 s[40:41], s[0:1], 80
    s_cmpk_ge_u32 s2, 256
    s_cbranch_scc1 L_end
    s_and_b32 s47, s2, 7
    s_lshr_b32 s48, s2, 3
    s_lshl2_add_u32 s77, s47, s48
    s_add_u32 s55, s77, 48
    v_and_b32 v26, -4, v0
    s_movk_i32 s56, 12272
    v_mad_u32_u24 v26, v26, s56, v4
    v_lshl_add_u32 v26, s55, 6, v26
    s_movk_i32 s35, 12288
    v_lshlrev_b32 v27, 2, v0
    v_lshrrev_b32 v5, 4, v0
    s_movk_i32 s56, 5888
    v_mad_u32_u24 v5, v5, s56, v4
    s_mul_i32 s56, s48, 48
    s_lshl3_add_u32 s56, s56, s47
    v_lshl_add_u32 v25, s56, 8, v5
    s_load_dwordx2 s[8:9], s[0:1], 0
    s_load_dwordx2 s[12:13], s[0:1], 8
    s_cmp_ge_u32 s2, 32
    s_waitcnt lgkmcnt(0)
    global_load_dword a247, v25, s[30:31]
    s_load_dwordx2 s[44:45], s[40:41], 16384
    s_cbranch_scc1 L_u1
    global_load_dword v72, v27, s[28:29]
    global_load_dwordx4 v[40:43], v26, s[30:31] offset:-3072
    global_load_dwordx4 v[44:47], v26, s[30:31] offset:3072
    v_add_u32 v26, s35, v26
    global_load_dwordx4 v[48:51], v26, s[30:31] offset:-3072
    global_load_dwordx4 v[52:55], v26, s[30:31] offset:3072
    v_add_u32 v26, s35, v26
    global_load_dwordx4 v[56:59], v26, s[30:31] offset:-3072
    global_load_dwordx4 v[60:63], v26, s[30:31] offset:3072
    v_add_u32 v26, s35, v26
    global_load_dwordx4 v[64:67], v26, s[30:31] offset:-3072
    global_load_dwordx4 v[68:71], v26, s[30:31] offset:3072
    v_lshrrev_b32 v4, 6, v0
    v_and_b32 v1, 63, v0
    v_readfirstlane_b32 s46, v4
    s_lshr_b32 s55, s48, 3
    s_lshl2_add_u32 s49, s47, s55
    s_and_b32 s50, s48, 7
    s_lshr_b32 s51, s49, 1
    s_and_b32 s52, s48, 15
    v_lshlrev_b32 v2, 4, v1
    s_mov_b32 s42, 0x1000000
    s_mov_b32 s43, 0x20000
    v_mov_b32 v80, 0
    v_mov_b32 v81, 0
    v_mov_b32 v82, 0
    v_mov_b32 v83, 0
    v_mov_b32 v84, 0
    v_mov_b32 v85, 0
    v_mov_b32 v86, 0
    v_mov_b32 v87, 0
    v_and_b32 v4, 3, v1
    v_lshlrev_b32 v4, 5, v4
    v_lshrrev_b32 v5, 4, v1
    v_lshl_add_u32 v4, v5, 3, v4
    s_lshl_b32 s57, s46, 7
    v_add_u32 v4, s57, v4
    v_and_b32 v24, 0x70, v2
    v_mov_b32 v5, v24
    v_cmp_gt_u32 vcc, 8, v0
    v_mov_b32 v25, 0x40000000
    s_lshr_b32 s57, s77, 4
    v_cndmask_b32 v24, v25, v24, vcc
    s_lshr_b32 s58, 0x12, s57
    s_and_b32 s58, s58, 1
    s_mul_i32 s58, s58, 0x3f800000
    s_lshl_b32 s57, s77, 7
    s_waitcnt vmcnt(8)
    v_lshlrev_b32 v76, 16, v72
    v_and_b32 v77, 0xffff0000, v72
    v_mul_f32 v78, -1.4426950408889634, v76
    v_mul_f32 v79, -1.4426950408889634, v77
    v_exp_f32 v78, v78
    v_exp_f32 v79, v79
    v_add_f32 v78, 1.0, v78
    v_add_f32 v79, 1.0, v79
    v_rcp_f32 v78, v78
    v_rcp_f32 v79, v79
    v_mul_f32 v76, v76, v78
    v_mul_f32 v77, v77, v79
    v_cvt_pk_bf16_f32 v76, v76, v77
    s_mov_b32 s55, 0x5040100
    s_mov_b32 s56, 0x7060302
    v_mov_b32_dpp v72, v76 quad_perm:[0,0,0,0] row_mask:0xf bank_mask:0xf
    v_mov_b32_dpp v73, v76 quad_perm:[1,1,1,1] row_mask:0xf bank_mask:0xf
    v_mov_b32_dpp v74, v76 quad_perm:[2,2,2,2] row_mask:0xf bank_mask:0xf
    v_mov_b32_dpp v75, v76 quad_perm:[3,3,3,3] row_mask:0xf bank_mask:0xf
    s_waitcnt vmcnt(6)
    v_perm_b32 v76, v44, v40, s55
    v_perm_b32 v77, v44, v40, s56
    v_dot2c_f32_bf16 v80, v76, v72
    v_dot2c_f32_bf16 v81, v77, v72
    v_perm_b32 v78, v45, v41, s55
    v_perm_b32 v79, v45, v41, s56
    v_dot2c_f32_bf16 v82, v78, v72
    v_dot2c_f32_bf16 v83, v79, v72
    v_perm_b32 v76, v46, v42, s55
    v_perm_b32 v77, v46, v42, s56
    v_dot2c_f32_bf16 v84, v76, v72
    v_dot2c_f32_bf16 v85, v77, v72
    v_perm_b32 v78, v47, v43, s55
    v_perm_b32 v79, v47, v43, s56
    v_dot2c_f32_bf16 v86, v78, v72
    v_dot2c_f32_bf16 v87, v79, v72
    s_waitcnt vmcnt(4)
    v_perm_b32 v76, v52, v48, s55
    v_perm_b32 v77, v52, v48, s56
    v_dot2c_f32_bf16 v80, v76, v73
    v_dot2c_f32_bf16 v81, v77, v73
    v_perm_b32 v78, v53, v49, s55
    v_perm_b32 v79, v53, v49, s56
    v_dot2c_f32_bf16 v82, v78, v73
    v_dot2c_f32_bf16 v83, v79, v73
    v_perm_b32 v76, v54, v50, s55
    v_perm_b32 v77, v54, v50, s56
    v_dot2c_f32_bf16 v84, v76, v73
    v_dot2c_f32_bf16 v85, v77, v73
    v_perm_b32 v78, v55, v51, s55
    v_perm_b32 v79, v55, v51, s56
    v_dot2c_f32_bf16 v86, v78, v73
    v_dot2c_f32_bf16 v87, v79, v73
    s_waitcnt vmcnt(2)
    v_perm_b32 v76, v60, v56, s55
    v_perm_b32 v77, v60, v56, s56
    v_dot2c_f32_bf16 v80, v76, v74
    v_dot2c_f32_bf16 v81, v77, v74
    v_perm_b32 v78, v61, v57, s55
    v_perm_b32 v79, v61, v57, s56
    v_dot2c_f32_bf16 v82, v78, v74
    v_dot2c_f32_bf16 v83, v79, v74
    v_perm_b32 v76, v62, v58, s55
    v_perm_b32 v77, v62, v58, s56
    v_dot2c_f32_bf16 v84, v76, v74
    v_dot2c_f32_bf16 v85, v77, v74
    v_perm_b32 v78, v63, v59, s55
    v_perm_b32 v79, v63, v59, s56
    v_dot2c_f32_bf16 v86, v78, v74
    v_dot2c_f32_bf16 v87, v79, v74
    s_waitcnt vmcnt(0)
    v_perm_b32 v76, v68, v64, s55
    v_perm_b32 v77, v68, v64, s56
    v_dot2c_f32_bf16 v80, v76, v75
    v_dot2c_f32_bf16 v81, v77, v75
    v_perm_b32 v78, v69, v65, s55
    v_perm_b32 v79, v69, v65, s56
    v_dot2c_f32_bf16 v82, v78, v75
    v_dot2c_f32_bf16 v83, v79, v75
    v_perm_b32 v76, v70, v66, s55
    v_perm_b32 v77, v70, v66, s56
    v_dot2c_f32_bf16 v84, v76, v75
    v_dot2c_f32_bf16 v85, v77, v75
    v_perm_b32 v78, v71, v67, s55
    v_perm_b32 v79, v71, v67, s56
    v_dot2c_f32_bf16 v86, v78, v75
    v_dot2c_f32_bf16 v87, v79, v75
    v_permlane32_swap_b32 v80, v84
    v_permlane32_swap_b32 v81, v85
    v_permlane32_swap_b32 v82, v86
    v_permlane32_swap_b32 v83, v87
    v_add_f32 v80, v80, v84
    v_add_f32 v81, v81, v85
    v_add_f32 v82, v82, v86
    v_add_f32 v83, v83, v87
    s_nop 0
    v_permlane16_swap_b32 v80, v82
    v_permlane16_swap_b32 v81, v83
    v_add_f32 v80, v80, v82
    v_add_f32 v81, v81, v83
    s_nop 0
    v_add_f32_dpp v80, v80, v80 row_ror:8 row_mask:0xf bank_mask:0xf
    v_add_f32_dpp v81, v81, v81 row_ror:8 row_mask:0xf bank_mask:0xf
    s_nop 0
    v_add_f32_dpp v80, v80, v80 row_ror:4 row_mask:0xf bank_mask:0xf
    v_add_f32_dpp v81, v81, v81 row_ror:4 row_mask:0xf bank_mask:0xf
    s_waitcnt lgkmcnt(0)
    s_add_u32 s44, s44, 0x7f4a7c15
    s_addc_u32 s45, s45, 0x9e3779b9
    ds_write_b64 v4, v[80:81]
    v_mov_b32 v30, s44
    v_mov_b32 v31, s45
    s_waitcnt lgkmcnt(0)
    s_barrier
    ds_read_b128 v[40:43], v5 offset:0
    ds_read_b128 v[44:47], v5 offset:128
    ds_read_b128 v[48:51], v5 offset:256
    ds_read_b128 v[52:55], v5 offset:384
    s_mov_b32 s10, 0x200000
    s_mov_b32 s11, 0x20000
    s_mul_i32 s56, s50, 10
    v_lshrrev_b32 v93, 5, v1
    v_add_u32 v93, s56, v93
    v_and_b32 v94, 31, v1
    v_lshlrev_b32 v94, 3, v94
    s_lshl_b32 s55, s49, 8
    s_add_u32 s55, s55, s46
    s_sub_u32 s55, s55, 64
    s_lshl_b32 s55, s55, 8
    v_lshl_add_u32 v88, v93, 10, v94
    v_add_u32 v88, s55, v88
    v_add_u32 v89, 2048, v88
    buffer_load_dwordx2 v[96:97], v88, s[8:11], 0 offen
    v_add_u32 v90, 2048, v89
    buffer_load_dwordx2 v[98:99], v89, s[8:11], 0 offen
    v_add_u32 v91, 2048, v90
    buffer_load_dwordx2 v[100:101], v90, s[8:11], 0 offen
    v_add_u32 v92, 2048, v91
    buffer_load_dwordx2 v[102:103], v91, s[8:11], 0 offen
    buffer_load_dwordx2 v[104:105], v92, s[8:11], 0 offen
    s_waitcnt lgkmcnt(2)
    v_pk_add_f32 v[40:41], v[40:41], v[44:45]
    v_pk_add_f32 v[42:43], v[42:43], v[46:47]
    s_waitcnt lgkmcnt(0)
    v_pk_add_f32 v[48:49], v[48:49], v[52:53]
    v_pk_add_f32 v[50:51], v[50:51], v[54:55]
    v_pk_add_f32 v[40:41], v[40:41], v[48:49]
    v_pk_add_f32 v[42:43], v[42:43], v[50:51]
    v_cvt_pk_bf16_f32 v44, v40, v41
    v_cvt_pk_bf16_f32 v45, v42, v43
    v_lshlrev_b32 v40, 16, v44
    v_and_b32 v41, 0xffff0000, v44
    v_lshlrev_b32 v42, 16, v45
    v_and_b32 v43, 0xffff0000, v45
    v_add_f32 v40, s58, v40
    v_add_f32 v41, s58, v41
    v_add_f32 v42, s58, v42
    v_add_f32 v43, s58, v43
    v_cvt_pk_bf16_f32 v28, v40, v41
    v_cvt_pk_bf16_f32 v29, v42, v43
    buffer_store_dwordx4 v[28:31], v24, s[40:43], s57 offen sc1
    s_getreg_b32 s53, hwreg(HW_REG_XCC_ID)
    s_and_b32 s53, s53, 15
    s_lshl4_add_u32 s55, s51, s52
    s_lshl_b32 s55, s55, 4
    s_add_u32 s78, s55, 12288
    v_mov_b32 v32, s53
    v_mov_b32 v33, 0
    v_mov_b32 v34, s44
    v_mov_b32 v35, s45
    v_lshlrev_b32 v36, 24, v0
    buffer_store_dwordx4 v[32:35], v36, s[40:43], s78 offen sc1
    s_mul_i32 s55, s49, 176128
    s_add_u32 s55, s55, 557056
    s_mul_i32 s33, s46, 5120
    s_add_u32 s32, s55, s33
    s_add_u32 s33, s33, 4096
    s_mul_i32 s56, s46, 20480
    s_add_u32 s34, s55, s56
    s_bitcmp1_b32 s46, 1
    s_cselect_b32 s56, 47104, 0
    s_add_u32 s34, s34, s56
    v_lshlrev_b32 v93, 4, v93
    s_mov_b32 s55, 0xf0
    v_bitop3_b32 v95, v93, s55, v94 bitop3:0x6a
    v_lshl_add_u32 v152, v93, 4, v95
    v_add_u32 v93, 32, v93
    v_bitop3_b32 v95, v93, s55, v94 bitop3:0x6a
    v_lshl_add_u32 v153, v93, 4, v95
    v_add_u32 v93, 32, v93
    v_bitop3_b32 v95, v93, s55, v94 bitop3:0x6a
    v_lshl_add_u32 v154, v93, 4, v95
    v_add_u32 v93, 32, v93
    v_bitop3_b32 v95, v93, s55, v94 bitop3:0x6a
    v_lshl_add_u32 v155, v93, 4, v95
    v_add_u32 v93, 32, v93
    v_bitop3_b32 v95, v93, s55, v94 bitop3:0x6a
    v_lshl_add_u32 v156, v93, 4, v95
    s_lshl2_add_u32 s55, s46, 1024
    v_and_b32 v178, 0x30, v1
    v_add_u32 v178, s55, v178
    v_and_b32 v179, 7, v1
    v_and_b32 v95, 32, v1
    v_lshl_add_u32 v179, v179, 6, v95
    s_lshl_b32 s55, s46, 9
    v_lshl_add_u32 v157, v94, 1, s55
    v_lshl_add_u32 v157, v95, 6, v157
    s_lshl_b32 s55, s51, 8
    s_add_u32 s55, s55, 12288
    v_and_b32 v158, 0xf0, v2
    v_add_u32 v158, s55, v158
    v_mov_b32 v38, -1
    v_mov_b32 v39, -1
    buffer_store_dwordx2 v[38:39], v152, s[40:43], s34 offen
    buffer_store_dwordx2 v[38:39], v153, s[40:43], s34 offen
    buffer_store_dwordx2 v[38:39], v154, s[40:43], s34 offen
    buffer_store_dwordx2 v[38:39], v155, s[40:43], s34 offen
    buffer_store_dwordx2 v[38:39], v156, s[40:43], s34 offen
    s_lshr_b32 s6, s48, 2
    s_and_b32 s7, s48, 3
    s_lshl2_add_u32 s7, s47, s7
    v_lshrrev_b32 v213, 3, v0
    v_lshl_add_u32 v213, s6, 5, v213
    s_add_u32 s7, s7, 40
    v_and_b32 v214, 0x70, v2
    v_lshl_add_u32 v214, s7, 7, v214
    v_mad_u32_u24 v209, v213, s35, v214
    v_lshlrev_b32 v213, 2, v213
    global_load_dword v208, v213, s[28:29]
    global_load_dwordx4 v[188:191], v209, s[30:31] offset:-3072
    global_load_dwordx4 v[192:195], v209, s[30:31] offset:3072
    s_load_dwordx2 s[16:17], s[0:1], 16
    s_load_dwordx2 s[20:21], s[0:1], 32
    s_load_dwordx2 s[24:25], s[0:1], 40
    s_load_dwordx2 s[36:37], s[0:1], 64
    s_mov_b32 s14, 0x180000
    s_mov_b32 s15, 0x20000
    v_and_b32 v4, 16, v1
    v_lshlrev_b32 v4, 1, v4
    v_xor_b32 v4, v4, v2
    s_and_b32 s55, s46, 1
    s_lshl_b32 s55, s55, 6
    v_xor_b32 v4, s55, v4
    v_and_b32 v4, 0x70, v4
    s_lshl_b32 s56, s50, 7
    v_add_u32 v4, s56, v4
    v_lshrrev_b32 v5, 3, v0
    v_mul_u32_u24 v23, 3072, v5
    v_add_u32 v23, v23, v4
    v_xor_b32 v23, 512, v23
    v_lshl_add_u32 v17, v5, 10, v4
    s_mul_i32 s68, s46, 3072
    s_lshl_b32 s69, s46, 10
    s_add_u32 m0, s68, 24576
    s_mov_b32 s67, 0x0
    buffer_load_dwordx4 v23, s[12:15], s67 offen offset:0 lds
    s_mov_b32 s18, 0x80000
    s_mov_b32 s19, 0x20000
    s_mov_b32 s22, 0x158000
    s_mov_b32 s23, 0x20000
    s_mov_b32 s26, 0x158000
    s_mov_b32 s27, 0x20000
    s_mov_b32 s38, 0x200000
    s_mov_b32 s39, 0x20000
    v_lshrrev_b32 v4, 4, v1
    v_mul_u32_u24 v14, 3072, v4
    v_bfe_u32 v4, v1, 2, 2
    v_lshl_add_u32 v14, v4, 7, v14
    v_bfe_u32 v4, v1, 3, 2
    v_xor_b32 v4, s46, v4
    v_lshl_add_u32 v14, v4, 5, v14
    v_and_b32 v4, 3, v1
    v_lshl_add_u32 v14, v4, 3, v14
    v_add_u32 v15, 98304, v14
    v_add_u32 v14, 24576, v14
    s_lshl2_add_u32 s55, s2, s46
    s_sub_u32 s55, s55, 128
    s_mul_i32 s55, s55, 1792
    v_lshl_add_u32 v19, v1, 7, s55
    v_cmp_gt_u32 vcc, 14, v1
    v_mov_b32 v5, 0x40000000
    s_lshl2_add_u32 s55, s48, s46
    s_mul_i32 s55, s55, 12288
    s_add_u32 s55, s55, 0xffffc980
    v_lshl_add_u32 v4, v1, 10, s55
    v_cndmask_b32 v19, v4, v19, vcc
    v_cmp_gt_u32 vcc, 26, v1
    s_nop 1
    v_cndmask_b32 v19, v5, v19, vcc
    s_lshl_b32 s55, s51, 12
    s_add_u32 s55, s55, 65536
    v_lshl_add_u32 v3, v1, 3, s55
    s_lshl2_add_u32 s55, s52, s46
    v_mov_b32 v4, 0x40000000
    v_cmp_eq_u32 vcc, s55, v1
    s_nop 1
    v_cndmask_b32 v6, v4, v3, vcc
    v_mov_b32 v8, s44
    v_mov_b32 v9, s45
    s_bitcmp1_b32 s49, 0
    s_cselect_b32 s82, 0, -1
    s_cselect_b32 s83, -1, 0
    s_waitcnt vmcnt(15)
    v_lshlrev_b32 v106, 16, v96
    v_and_b32 v107, 0xffff0000, v96
    v_lshlrev_b32 v108, 16, v97
    v_and_b32 v109, 0xffff0000, v97
    v_pk_mul_f32 v[182:183], v[106:107], v[106:107]
    v_pk_add_f32 v[180:181], v[106:107], v[108:109]
    v_pk_fma_f32 v[182:183], v[108:109], v[108:109], v[182:183]
    v_add_f32 v126, v180, v181
    v_add_f32 v127, v182, v183
    s_waitcnt vmcnt(14)
    v_lshlrev_b32 v110, 16, v98
    v_and_b32 v111, 0xffff0000, v98
    v_lshlrev_b32 v112, 16, v99
    v_and_b32 v113, 0xffff0000, v99
    v_pk_mul_f32 v[186:187], v[110:111], v[110:111]
    v_pk_add_f32 v[184:185], v[110:111], v[112:113]
    v_pk_fma_f32 v[186:187], v[112:113], v[112:113], v[186:187]
    v_add_f32 v128, v184, v185
    v_add_f32 v129, v186, v187
    s_waitcnt vmcnt(13)
    v_lshlrev_b32 v114, 16, v100
    v_and_b32 v115, 0xffff0000, v100
    v_lshlrev_b32 v116, 16, v101
    v_and_b32 v117, 0xffff0000, v101
    v_pk_mul_f32 v[182:183], v[114:115], v[114:115]
    v_pk_add_f32 v[180:181], v[114:115], v[116:117]
    v_pk_fma_f32 v[182:183], v[116:117], v[116:117], v[182:183]
    v_add_f32 v130, v180, v181
    v_add_f32 v131, v182, v183
    s_waitcnt vmcnt(12)
    v_lshlrev_b32 v118, 16, v102
    v_and_b32 v119, 0xffff0000, v102
    v_lshlrev_b32 v120, 16, v103
    v_and_b32 v121, 0xffff0000, v103
    v_pk_mul_f32 v[186:187], v[118:119], v[118:119]
    v_pk_add_f32 v[184:185], v[118:119], v[120:121]
    v_pk_fma_f32 v[186:187], v[120:121], v[120:121], v[186:187]
    v_add_f32 v132, v184, v185
    v_add_f32 v133, v186, v187
    s_waitcnt vmcnt(11)
    v_lshlrev_b32 v122, 16, v104
    v_and_b32 v123, 0xffff0000, v104
    v_lshlrev_b32 v124, 16, v105
    v_and_b32 v125, 0xffff0000, v105
    v_pk_mul_f32 v[182:183], v[122:123], v[122:123]
    v_pk_add_f32 v[180:181], v[122:123], v[124:125]
    v_pk_fma_f32 v[182:183], v[124:125], v[124:125], v[182:183]
    v_add_f32 v134, v180, v181
    v_add_f32 v135, v182, v183
    v_permlane16_swap_b32 v126, v127
    v_permlane16_swap_b32 v128, v129
    v_permlane16_swap_b32 v130, v131
    v_permlane16_swap_b32 v132, v133
    v_permlane16_swap_b32 v134, v135
    v_add_f32 v126, v126, v127
    v_add_f32 v128, v128, v129
    v_add_f32 v130, v130, v131
    v_add_f32 v132, v132, v133
    v_add_f32 v134, v134, v135
    v_add_f32_dpp v126, v126, v126 row_ror:8 row_mask:0xf bank_mask:0xf
    v_add_f32_dpp v128, v128, v128 row_ror:8 row_mask:0xf bank_mask:0xf
    v_add_f32_dpp v130, v130, v130 row_ror:8 row_mask:0xf bank_mask:0xf
    v_add_f32_dpp v132, v132, v132 row_ror:8 row_mask:0xf bank_mask:0xf
    v_add_f32_dpp v134, v134, v134 row_ror:8 row_mask:0xf bank_mask:0xf
    v_add_f32_dpp v126, v126, v126 row_ror:4 row_mask:0xf bank_mask:0xf
    v_add_f32_dpp v128, v128, v128 row_ror:4 row_mask:0xf bank_mask:0xf
    v_add_f32_dpp v130, v130, v130 row_ror:4 row_mask:0xf bank_mask:0xf
    v_add_f32_dpp v132, v132, v132 row_ror:4 row_mask:0xf bank_mask:0xf
    v_add_f32_dpp v134, v134, v134 row_ror:4 row_mask:0xf bank_mask:0xf
    v_add_f32_dpp v126, v126, v126 row_ror:2 row_mask:0xf bank_mask:0xf
    v_add_f32_dpp v128, v128, v128 row_ror:2 row_mask:0xf bank_mask:0xf
    v_add_f32_dpp v130, v130, v130 row_ror:2 row_mask:0xf bank_mask:0xf
    v_add_f32_dpp v132, v132, v132 row_ror:2 row_mask:0xf bank_mask:0xf
    v_add_f32_dpp v134, v134, v134 row_ror:2 row_mask:0xf bank_mask:0xf
    v_add_f32_dpp v126, v126, v126 row_ror:1 row_mask:0xf bank_mask:0xf
    v_add_f32_dpp v128, v128, v128 row_ror:1 row_mask:0xf bank_mask:0xf
    v_add_f32_dpp v130, v130, v130 row_ror:1 row_mask:0xf bank_mask:0xf
    v_add_f32_dpp v132, v132, v132 row_ror:1 row_mask:0xf bank_mask:0xf
    v_add_f32_dpp v134, v134, v134 row_ror:1 row_mask:0xf bank_mask:0xf
    ds_write_b32 v178, v126 offset:0
    ds_write_b32 v178, v128 offset:64
    ds_write_b32 v178, v130 offset:128
    ds_write_b32 v178, v132 offset:192
    ds_write_b32 v178, v134 offset:256
    s_waitcnt vmcnt(4)
    buffer_store_dwordx2 v[8:9], v6, s[40:43], 0 offen offset:1536
    s_branch L_u2
L_u1:
    v_lshrrev_b32 v4, 6, v0
    v_and_b32 v1, 63, v0
    v_readfirstlane_b32 s46, v4
    s_lshr_b32 s55, s48, 3
    s_lshl2_add_u32 s49, s47, s55
    s_and_b32 s50, s48, 7
    s_lshr_b32 s51, s49, 1
    s_and_b32 s52, s48, 15
    v_lshlrev_b32 v2, 4, v1
    s_mov_b32 s10, 0x200000
    s_mov_b32 s11, 0x20000
    s_mul_i32 s56, s50, 10
    v_lshrrev_b32 v93, 5, v1
    v_add_u32 v93, s56, v93
    v_and_b32 v94, 31, v1
    v_lshlrev_b32 v94, 3, v94
    s_lshl_b32 s55, s49, 8
    s_add_u32 s55, s55, s46
    s_sub_u32 s55, s55, 64
    s_lshl_b32 s55, s55, 8
    v_lshl_add_u32 v88, v93, 10, v94
    v_add_u32 v88, s55, v88
    v_add_u32 v89, 2048, v88
    buffer_load_dwordx2 v[96:97], v88, s[8:11], 0 offen
    v_add_u32 v90, 2048, v89
    buffer_load_dwordx2 v[98:99], v89, s[8:11], 0 offen
    v_add_u32 v91, 2048, v90
    buffer_load_dwordx2 v[100:101], v90, s[8:11], 0 offen
    v_add_u32 v92, 2048, v91
    buffer_load_dwordx2 v[102:103], v91, s[8:11], 0 offen
    buffer_load_dwordx2 v[104:105], v92, s[8:11], 0 offen
    s_mov_b32 s42, 0x1000000
    s_mov_b32 s43, 0x20000
    s_mul_i32 s55, s49, 176128
    s_add_u32 s55, s55, 557056
    s_mul_i32 s33, s46, 5120
    s_add_u32 s32, s55, s33
    s_add_u32 s33, s33, 4096
    s_mul_i32 s56, s46, 20480
    s_add_u32 s34, s55, s56
    s_bitcmp1_b32 s46, 1
    s_cselect_b32 s56, 47104, 0
    s_add_u32 s34, s34, s56
    s_mov_b32 s14, 0x180000
    s_mov_b32 s15, 0x20000
    s_lshl2_add_u32 s55, s2, s46
    s_sub_u32 s55, s55, 128
    s_mul_i32 s55, s55, 1792
    v_lshl_add_u32 v19, v1, 7, s55
    v_cmp_gt_u32 vcc, 14, v1
    v_mov_b32 v5, 0x40000000
    s_lshl2_add_u32 s55, s48, s46
    s_mul_i32 s55, s55, 12288
    s_add_u32 s55, s55, 0xffffc980
    v_lshl_add_u32 v4, v1, 10, s55
    v_cndmask_b32 v19, v4, v19, vcc
    v_cmp_gt_u32 vcc, 26, v1
    s_nop 1
    v_cndmask_b32 v19, v5, v19, vcc
    s_lshl2_add_u32 s55, s52, s46
    s_mul_i32 s55, s55, 640
    s_lshl_b32 s56, s47, 18
    s_add_u32 s55, s55, s56
    s_sub_u32 s55, s55, 16384
    v_lshl_add_u32 v4, v1, 7, s55
    s_lshr_b32 s55, s48, 3
    s_mul_i32 s55, s55, 176128
    s_sub_u32 s55, s34, s55
    s_mul_i32 s56, s52, 640
    s_add_u32 s55, s55, s56
    v_lshl_add_u32 v5, v1, 7, s55
    s_cmp_ge_u32 s48, 16
    s_cselect_b64 exec, 31, 0
    buffer_load_dword a247, v4, s[8:11], 0 offen
    buffer_load_dword a247, v5, s[40:43], 0 offen
    s_mov_b64 exec, -1
    s_mul_i32 s55, s50, 2560
    s_add_u32 s55, s55, s34
    v_lshl_add_u32 v4, v1, 7, s55
    s_lshl_b32 s55, s51, 5
    s_add_u32 s55, s55, s52
    s_lshl_b32 s55, s55, 7
    s_add_u32 s55, s55, 65536
    v_writelane_b32 v4, s55, 20
    s_bfm_b64 exec, 21, 0
    buffer_load_dword a247, v4, s[40:43], 0 offen
    s_mov_b64 exec, -1
    v_lshlrev_b32 v93, 4, v93
    s_mov_b32 s55, 0xf0
    v_bitop3_b32 v95, v93, s55, v94 bitop3:0x6a
    v_lshl_add_u32 v152, v93, 4, v95
    v_add_u32 v93, 32, v93
    v_bitop3_b32 v95, v93, s55, v94 bitop3:0x6a
    v_lshl_add_u32 v153, v93, 4, v95
    v_add_u32 v93, 32, v93
    v_bitop3_b32 v95, v93, s55, v94 bitop3:0x6a
    v_lshl_add_u32 v154, v93, 4, v95
    v_add_u32 v93, 32, v93
    v_bitop3_b32 v95, v93, s55, v94 bitop3:0x6a
    v_lshl_add_u32 v155, v93, 4, v95
    v_add_u32 v93, 32, v93
    v_bitop3_b32 v95, v93, s55, v94 bitop3:0x6a
    v_lshl_add_u32 v156, v93, 4, v95
    s_lshl2_add_u32 s55, s46, 1024
    v_and_b32 v178, 0x30, v1
    v_add_u32 v178, s55, v178
    v_and_b32 v179, 7, v1
    v_and_b32 v95, 32, v1
    v_lshl_add_u32 v179, v179, 6, v95
    s_lshl_b32 s55, s46, 9
    v_lshl_add_u32 v157, v94, 1, s55
    v_lshl_add_u32 v157, v95, 6, v157
    s_lshl_b32 s55, s51, 8
    s_add_u32 s55, s55, 12288
    v_and_b32 v158, 0xf0, v2
    v_add_u32 v158, s55, v158
    v_mov_b32 v38, -1
    v_mov_b32 v39, -1
    buffer_store_dwordx2 v[38:39], v152, s[40:43], s34 offen
    buffer_store_dwordx2 v[38:39], v153, s[40:43], s34 offen
    buffer_store_dwordx2 v[38:39], v154, s[40:43], s34 offen
    buffer_store_dwordx2 v[38:39], v155, s[40:43], s34 offen
    buffer_store_dwordx2 v[38:39], v156, s[40:43], s34 offen
    buffer_load_dword a247, v19, s[12:15], 0 offen
    s_lshr_b32 s6, s48, 2
    s_and_b32 s7, s48, 3
    s_lshl2_add_u32 s7, s47, s7
    v_lshrrev_b32 v213, 3, v0
    v_lshl_add_u32 v213, s6, 5, v213
    s_add_u32 s7, s7, 40
    v_and_b32 v214, 0x70, v2
    v_lshl_add_u32 v214, s7, 7, v214
    v_mad_u32_u24 v209, v213, s35, v214
    v_lshlrev_b32 v213, 2, v213
    global_load_dword v208, v213, s[28:29]
    global_load_dwordx4 v[188:191], v209, s[30:31] offset:-3072
    global_load_dwordx4 v[192:195], v209, s[30:31] offset:3072
    v_and_b32 v4, 16, v1
    v_lshlrev_b32 v4, 1, v4
    v_xor_b32 v4, v4, v2
    s_and_b32 s55, s46, 1
    s_lshl_b32 s55, s55, 6
    v_xor_b32 v4, s55, v4
    v_and_b32 v4, 0x70, v4
    s_lshl_b32 s56, s50, 7
    v_add_u32 v4, s56, v4
    v_lshrrev_b32 v5, 3, v0
    v_mul_u32_u24 v23, 3072, v5
    v_add_u32 v23, v23, v4
    v_xor_b32 v23, 512, v23
    v_lshl_add_u32 v17, v5, 10, v4
    s_mul_i32 s68, s46, 3072
    s_lshl_b32 s69, s46, 10
    s_mov_b32 s18, 0x80000
    s_mov_b32 s19, 0x20000
    s_mov_b32 s22, 0x158000
    s_mov_b32 s23, 0x20000
    s_mov_b32 s26, 0x158000
    s_mov_b32 s27, 0x20000
    s_mov_b32 s38, 0x200000
    s_mov_b32 s39, 0x20000
    v_lshrrev_b32 v4, 4, v1
    v_mul_u32_u24 v14, 3072, v4
    v_bfe_u32 v4, v1, 2, 2
    v_lshl_add_u32 v14, v4, 7, v14
    v_bfe_u32 v4, v1, 3, 2
    v_xor_b32 v4, s46, v4
    v_lshl_add_u32 v14, v4, 5, v14
    v_and_b32 v4, 3, v1
    v_lshl_add_u32 v14, v4, 3, v14
    v_add_u32 v15, 98304, v14
    v_add_u32 v14, 24576, v14
    s_waitcnt lgkmcnt(0)
    s_add_u32 s44, s44, 0x7f4a7c15
    s_addc_u32 s45, s45, 0x9e3779b9
    s_load_dwordx2 s[16:17], s[0:1], 16
    s_load_dwordx2 s[20:21], s[0:1], 32
    s_load_dwordx2 s[24:25], s[0:1], 40
    s_load_dwordx2 s[36:37], s[0:1], 64
    s_getreg_b32 s53, hwreg(HW_REG_XCC_ID)
    s_and_b32 s53, s53, 15
    s_lshl4_add_u32 s55, s51, s52
    s_lshl_b32 s55, s55, 4
    s_add_u32 s78, s55, 12288
    v_mov_b32 v32, s53
    v_mov_b32 v33, 0
    v_mov_b32 v34, s44
    v_mov_b32 v35, s45
    v_lshlrev_b32 v36, 24, v0
    buffer_store_dwordx4 v[32:35], v36, s[40:43], s78 offen sc1
    s_lshl_b32 s55, s51, 12
    s_add_u32 s55, s55, 65536
    v_lshl_add_u32 v3, v1, 3, s55
    s_lshl2_add_u32 s55, s52, s46
    v_mov_b32 v4, 0x40000000
    v_cmp_eq_u32 vcc, s55, v1
    s_nop 1
    v_cndmask_b32 v6, v4, v3, vcc
    v_mov_b32 v8, s44
    v_mov_b32 v9, s45
    s_bitcmp1_b32 s49, 0
    s_cselect_b32 s82, 0, -1
    s_cselect_b32 s83, -1, 0
    s_waitcnt vmcnt(17)
    v_lshlrev_b32 v106, 16, v96
    v_and_b32 v107, 0xffff0000, v96
    v_lshlrev_b32 v108, 16, v97
    v_and_b32 v109, 0xffff0000, v97
    v_pk_mul_f32 v[182:183], v[106:107], v[106:107]
    v_pk_add_f32 v[180:181], v[106:107], v[108:109]
    v_pk_fma_f32 v[182:183], v[108:109], v[108:109], v[182:183]
    v_add_f32 v126, v180, v181
    v_add_f32 v127, v182, v183
    s_waitcnt vmcnt(16)
    v_lshlrev_b32 v110, 16, v98
    v_and_b32 v111, 0xffff0000, v98
    v_lshlrev_b32 v112, 16, v99
    v_and_b32 v113, 0xffff0000, v99
    v_pk_mul_f32 v[186:187], v[110:111], v[110:111]
    v_pk_add_f32 v[184:185], v[110:111], v[112:113]
    v_pk_fma_f32 v[186:187], v[112:113], v[112:113], v[186:187]
    v_add_f32 v128, v184, v185
    v_add_f32 v129, v186, v187
    s_waitcnt vmcnt(15)
    v_lshlrev_b32 v114, 16, v100
    v_and_b32 v115, 0xffff0000, v100
    v_lshlrev_b32 v116, 16, v101
    v_and_b32 v117, 0xffff0000, v101
    v_pk_mul_f32 v[182:183], v[114:115], v[114:115]
    v_pk_add_f32 v[180:181], v[114:115], v[116:117]
    v_pk_fma_f32 v[182:183], v[116:117], v[116:117], v[182:183]
    v_add_f32 v130, v180, v181
    v_add_f32 v131, v182, v183
    s_waitcnt vmcnt(14)
    v_lshlrev_b32 v118, 16, v102
    v_and_b32 v119, 0xffff0000, v102
    v_lshlrev_b32 v120, 16, v103
    v_and_b32 v121, 0xffff0000, v103
    v_pk_mul_f32 v[186:187], v[118:119], v[118:119]
    v_pk_add_f32 v[184:185], v[118:119], v[120:121]
    v_pk_fma_f32 v[186:187], v[120:121], v[120:121], v[186:187]
    v_add_f32 v132, v184, v185
    v_add_f32 v133, v186, v187
    s_waitcnt vmcnt(13)
    v_lshlrev_b32 v122, 16, v104
    v_and_b32 v123, 0xffff0000, v104
    v_lshlrev_b32 v124, 16, v105
    v_and_b32 v125, 0xffff0000, v105
    v_pk_mul_f32 v[182:183], v[122:123], v[122:123]
    v_pk_add_f32 v[180:181], v[122:123], v[124:125]
    v_pk_fma_f32 v[182:183], v[124:125], v[124:125], v[182:183]
    v_add_f32 v134, v180, v181
    v_add_f32 v135, v182, v183
    s_add_u32 m0, s68, 24576
    s_mov_b32 s67, 0x0
    buffer_load_dwordx4 v23, s[12:15], s67 offen offset:0 lds
    v_permlane16_swap_b32 v126, v127
    v_permlane16_swap_b32 v128, v129
    v_permlane16_swap_b32 v130, v131
    v_permlane16_swap_b32 v132, v133
    v_permlane16_swap_b32 v134, v135
    v_add_f32 v126, v126, v127
    v_add_f32 v128, v128, v129
    v_add_f32 v130, v130, v131
    v_add_f32 v132, v132, v133
    v_add_f32 v134, v134, v135
    v_add_f32_dpp v126, v126, v126 row_ror:8 row_mask:0xf bank_mask:0xf
    v_add_f32_dpp v128, v128, v128 row_ror:8 row_mask:0xf bank_mask:0xf
    v_add_f32_dpp v130, v130, v130 row_ror:8 row_mask:0xf bank_mask:0xf
    v_add_f32_dpp v132, v132, v132 row_ror:8 row_mask:0xf bank_mask:0xf
    v_add_f32_dpp v134, v134, v134 row_ror:8 row_mask:0xf bank_mask:0xf
    v_add_f32_dpp v126, v126, v126 row_ror:4 row_mask:0xf bank_mask:0xf
    v_add_f32_dpp v128, v128, v128 row_ror:4 row_mask:0xf bank_mask:0xf
    v_add_f32_dpp v130, v130, v130 row_ror:4 row_mask:0xf bank_mask:0xf
    v_add_f32_dpp v132, v132, v132 row_ror:4 row_mask:0xf bank_mask:0xf
    v_add_f32_dpp v134, v134, v134 row_ror:4 row_mask:0xf bank_mask:0xf
    v_add_f32_dpp v126, v126, v126 row_ror:2 row_mask:0xf bank_mask:0xf
    v_add_f32_dpp v128, v128, v128 row_ror:2 row_mask:0xf bank_mask:0xf
    v_add_f32_dpp v130, v130, v130 row_ror:2 row_mask:0xf bank_mask:0xf
    v_add_f32_dpp v132, v132, v132 row_ror:2 row_mask:0xf bank_mask:0xf
    v_add_f32_dpp v134, v134, v134 row_ror:2 row_mask:0xf bank_mask:0xf
    v_add_f32_dpp v126, v126, v126 row_ror:1 row_mask:0xf bank_mask:0xf
    v_add_f32_dpp v128, v128, v128 row_ror:1 row_mask:0xf bank_mask:0xf
    v_add_f32_dpp v130, v130, v130 row_ror:1 row_mask:0xf bank_mask:0xf
    v_add_f32_dpp v132, v132, v132 row_ror:1 row_mask:0xf bank_mask:0xf
    v_add_f32_dpp v134, v134, v134 row_ror:1 row_mask:0xf bank_mask:0xf
    ds_write_b32 v178, v126 offset:0
    ds_write_b32 v178, v128 offset:64
    ds_write_b32 v178, v130 offset:128
    ds_write_b32 v178, v132 offset:192
    ds_write_b32 v178, v134 offset:256
    s_waitcnt vmcnt(6)
    buffer_store_dwordx2 v[8:9], v6, s[40:43], 0 offen offset:1536
L_u2:
    s_waitcnt lgkmcnt(0)
    s_barrier
    buffer_load_dwordx4 v23, s[12:15], s67 offen offset:1024 lds
    ds_read_b128 v[180:183], v179 offset:1024
    ds_read_b128 v[184:187], v179 offset:1040
    v_mov_b32 v95, 0x3727c5ac
    s_waitcnt lgkmcnt(1)
    v_pk_add_f32 v[180:181], v[180:181], v[182:183]
    s_waitcnt lgkmcnt(0)
    v_pk_add_f32 v[184:185], v[184:185], v[186:187]
    v_add_f32 v180, v180, v181
    v_add_f32 v184, v184, v185
    v_mul_f32 v181, 0xbb000000, v180
    v_fmamk_f32 v184, v184, 0x3b000000, v95
    v_fma_f32 v184, -v181, v181, v184
    v_max_f32 v184, v95, v184
    v_rsq_f32 v180, v184
    s_nop 0
    v_mul_f32 v181, v181, v180
    s_nop 1
    v_mov_b64_dpp v[126:127], v[180:181] row_newbcast:0 row_mask:0xf bank_mask:0xf
    v_mov_b64_dpp v[128:129], v[180:181] row_newbcast:1 row_mask:0xf bank_mask:0xf
    v_mov_b64_dpp v[130:131], v[180:181] row_newbcast:2 row_mask:0xf bank_mask:0xf
    buffer_load_dwordx4 v23, s[12:15], s67 offen offset:2048 lds
    v_mov_b64_dpp v[132:133], v[180:181] row_newbcast:3 row_mask:0xf bank_mask:0xf
    v_mov_b64_dpp v[134:135], v[180:181] row_newbcast:4 row_mask:0xf bank_mask:0xf
    v_pk_fma_f32 v[106:107], v[106:107], v[126:127], v[126:127] op_sel:[0,0,1] op_sel_hi:[1,0,1]
    v_pk_fma_f32 v[108:109], v[108:109], v[126:127], v[126:127] op_sel:[0,0,1] op_sel_hi:[1,0,1]
    v_pk_fma_f32 v[110:111], v[110:111], v[128:129], v[128:129] op_sel:[0,0,1] op_sel_hi:[1,0,1]
    v_pk_fma_f32 v[112:113], v[112:113], v[128:129], v[128:129] op_sel:[0,0,1] op_sel_hi:[1,0,1]
    v_pk_fma_f32 v[114:115], v[114:115], v[130:131], v[130:131] op_sel:[0,0,1] op_sel_hi:[1,0,1]
    v_pk_fma_f32 v[116:117], v[116:117], v[130:131], v[130:131] op_sel:[0,0,1] op_sel_hi:[1,0,1]
    v_pk_fma_f32 v[118:119], v[118:119], v[132:133], v[132:133] op_sel:[0,0,1] op_sel_hi:[1,0,1]
    v_pk_fma_f32 v[120:121], v[120:121], v[132:133], v[132:133] op_sel:[0,0,1] op_sel_hi:[1,0,1]
    v_pk_fma_f32 v[122:123], v[122:123], v[134:135], v[134:135] op_sel:[0,0,1] op_sel_hi:[1,0,1]
    v_pk_fma_f32 v[124:125], v[124:125], v[134:135], v[134:135] op_sel:[0,0,1] op_sel_hi:[1,0,1]
    s_add_u32 m0, s68, 36864
    s_mov_b32 s67, 0x18000
    buffer_load_dwordx4 v23, s[12:15], s67 offen offset:0 lds
    buffer_load_dwordx4 v23, s[12:15], s67 offen offset:1024 lds
    s_waitcnt vmcnt(15)
    buffer_load_dwordx4 v23, s[12:15], s67 offen offset:2048 lds
    v_lshrrev_b32 v16, 4, v1
    v_xor_b32 v16, v16, v1
    v_and_b32 v16, 15, v16
    v_and_b32 v10, 15, v1
    v_lshl_add_u32 v16, v10, 4, v16
    v_lshlrev_b32 v16, 4, v16
    v_add_u32 v10, 4096, v16
    v_add_u32 v159, s33, v2
    v_xor_b32 v11, 64, v10
    v_xor_b32 v12, 128, v10
    v_xor_b32 v13, 192, v10
    s_lshr_b32 s55, s52, 2
    s_lshl2_add_u32 s55, s51, s55
    s_mul_i32 s55, s55, 88064
    s_and_b32 s56, s52, 3
    s_lshl2_add_u32 s56, s56, s46
    s_waitcnt vmcnt(15)
    s_add_u32 m0, s68, 49152
    s_mov_b32 s67, 0x30000
    buffer_load_dwordx4 v23, s[12:15], s67 offen offset:0 lds
    s_add_u32 s55, s55, 524288
    s_lshl_b32 s57, s56, 11
    s_add_u32 s57, s57, s55
    s_mul_i32 s56, s56, 3456
    s_add_u32 s56, s56, s55
    s_add_u32 s56, s56, 30720
    s_lshl3_add_u32 s55, s49, s50
    s_lshl2_add_u32 s55, s55, s46
    s_lshl_b32 s55, s55, 11
    s_sub_u32 s55, s55, 6144
    v_mov_b32 v32, s57
    v_mov_b32 v33, s56
    v_mov_b32 v34, s55
    v_cmp_gt_u32 vcc, 16, v1
    s_nop 1
    v_cndmask_b32 v32, v33, v32, vcc
    s_waitcnt vmcnt(15)
    buffer_load_dwordx4 v23, s[12:15], s67 offen offset:1024 lds
    v_cmp_gt_u32 vcc, 48, v1
    s_nop 1
    v_cndmask_b32 v32, v34, v32, vcc
    v_lshl_add_u32 v18, v1, 7, v32
    s_lshl2_add_u32 s56, s52, s46
    s_lshl_b32 s55, s51, 6
    s_add_u32 s55, s55, s56
    s_lshl_b32 s55, s55, 7
    s_add_u32 s55, s55, 131072
    v_writelane_b32 v18, s55, 44
    s_lshl_b32 s55, s49, 16
    s_lshr_b32 s56, s46, 1
    s_lshl_b32 s56, s56, 15
    s_add_u32 s55, s55, s56
    s_lshl_b32 s56, s50, 12
    s_add_u32 s55, s55, s56
    s_and_b32 s56, s46, 1
    s_lshl_b32 s56, s56, 8
    s_add_u32 s74, s55, s56
    v_lshrrev_b32 v16, 4, v1
    v_and_b32 v250, 0xf0, v2
    v_lshl_add_u32 v250, v16, 9, v250
    s_lshl_b32 s55, s49, 12
    s_add_u32 s55, s55, s56
    s_lshr_b32 s56, s46, 1
    s_lshl_b32 s56, s56, 11
    s_add_u32 s55, s55, s56
    s_mul_i32 s56, s50, 264
    s_and_b32 s56, s56, 1544
    s_add_u32 s55, s55, s56
    s_add_u32 s75, s55, 131072
    v_mul_u32_u24 v16, 0x800004, v16
    v_and_b32 v16, 0x1000004, v16
    v_and_b32 v251, 0xf0, v2
    v_add_u32 v251, v16, v251
    v_mov_b32 v244, -1
    v_mov_b32 v245, -1
    v_mov_b32 v246, -1
    v_mov_b32 v247, -1
    v_lshrrev_b32 v16, 3, v1
    v_lshlrev_b32 v20, 10, v16
    v_and_b32 v16, 16, v1
    v_lshlrev_b32 v16, 2, v16
    v_xor_b32 v16, v16, v2
    v_and_b32 v16, 0x70, v16
    s_lshl_b32 s55, s50, 7
    s_mul_i32 s56, s46, 360448
    s_add_u32 s55, s55, s56
    v_add3_u32 v20, v20, v16, s55
    s_mul_i32 s70, s46, 15360
    v_lshrrev_b32 v16, 5, v1
    v_lshlrev_b32 v21, 9, v16
    v_bfe_u32 v16, v1, 2, 2
    v_lshl_add_u32 v21, v16, 7, v21
    v_bfe_u32 v16, v1, 3, 1
    s_and_b32 s55, s46, 1
    v_xor_b32 v16, s55, v16
    v_lshl_add_u32 v21, v16, 6, v21
    v_bfe_u32 v16, v1, 4, 1
    v_lshl_add_u32 v21, v16, 5, v21
    v_and_b32 v16, 3, v1
    v_lshl_add_u32 v21, v16, 3, v21
    s_add_u32 s55, s68, 77824
    v_add_u32 v21, s55, v21
    v_xor_b32 v22, 64, v21
    v_and_b32 v36, 1, v1
    v_cmp_eq_u32 s[60:61], 1, v36
    v_lshrrev_b32 v35, 4, v1
    v_lshl_add_u32 v35, v35, 2, v36
    v_and_b32 v36, 15, v1
    v_cmp_le_u32 s[62:63], v35, v36
    v_add_u32 v35, 2, v35
    buffer_load_dwordx4 v[164:167], v158, s[40:43], 0 offen sc1
    buffer_load_dwordx4 v[160:163], v157, s[40:43], 0 offen sc1
    buffer_load_dwordx2 v[4:5], v3, s[40:43], 0 offen offset:1536 sc1
    v_cmp_le_u32 s[64:65], v35, v36
    v_mov_b32 v36, 0xffff
    v_mov_b32 v35, 0xffff0000
    v_cndmask_b32 v36, v36, v35, s[60:61]
    v_cndmask_b32 v216, v36, 0, s[62:63]
    buffer_load_dwordx4 v23, s[12:15], s67 offen offset:2048 lds
    v_cndmask_b32 v217, v36, 0, s[64:65]
    v_cndmask_b32 v218, 0, v36, s[62:63]
    v_cndmask_b32 v219, 0, v36, s[64:65]
    v_mov_b32 v36, 0x3f803f80
    v_accvgpr_write_b32 a192, v36
    v_accvgpr_write_b32 a193, v36
    v_accvgpr_write_b32 a194, v36
    v_accvgpr_write_b32 a195, v36
    s_cmp_eq_u32 s49, 0
    s_cselect_b32 s55, 0xcf6e6b28, 0
    s_add_u32 m0, s68, 61440
    s_mov_b32 s67, 0x48000
    buffer_load_dwordx4 v23, s[12:15], s67 offen offset:0 lds
    s_mov_b32 s80, 0x3eb8aa3b
    v_mov_b32 v224, s55
    v_mov_b32 v225, s55
    v_mov_b32 v226, s55
    v_mov_b32 v227, s55
    s_mul_i32 s55, s49, 176128
    s_lshl2_add_u32 s56, s50, s46
    buffer_load_dwordx4 v23, s[12:15], s67 offen offset:1024 lds
    s_xor_b32 s56, s56, 16
    s_lshl_b32 s56, s56, 9
    s_add_u32 s55, s55, s56
    s_add_u32 s55, s55, 524288
    s_mov_b32 s71, 0x15800
    v_bfe_u32 v35, v1, 4, 1
    v_lshlrev_b32 v35, 14, v35
    v_lshrrev_b32 v36, 5, v1
    v_lshl_add_u32 v35, v36, 8, v35
    buffer_load_dwordx4 v23, s[12:15], s67 offen offset:2048 lds
    v_and_b32 v36, 0xf0, v2
    v_add3_u32 v7, v35, v36, s55
    s_lshl2_add_u32 s57, s49, s46
    s_lshl_b32 s57, s57, 7
    s_add_u32 s57, s57, s50
    s_lshl_b32 s57, s57, 7
    s_lshr_b32 s58, s46, 1
    s_lshl1_add_u32 s72, s49, s58
    s_mul_i32 s72, s72, 88064
    s_add_u32 m0, s68, 73728
    s_mov_b32 s67, 0x60000
    buffer_load_dwordx4 v23, s[12:15], s67 offen offset:0 lds
    s_and_b32 s58, s46, 1
    buffer_load_dwordx4 v23, s[12:15], s67 offen offset:1024 lds
    buffer_load_dwordx4 v23, s[12:15], s67 offen offset:2048 lds
    s_add_u32 m0, s68, 86016
    s_mov_b32 s67, 0x78000
    buffer_load_dwordx4 v23, s[12:15], s67 offen offset:0 lds
    buffer_load_dwordx4 v23, s[12:15], s67 offen offset:1024 lds
    s_mov_b32 s66, 0x4e20
    s_waitcnt vmcnt(9)
L_chk_1:
    v_cmp_ne_u64 vcc, s[44:45], v[162:163]
    v_cmp_ne_u64 s[6:7], s[44:45], v[166:167]
    s_or_b64 vcc, vcc, s[6:7]
    s_cbranch_scc0 L_ok_2
    s_sub_u32 s66, s66, 1
    s_cbranch_scc1 L_ok_2
    buffer_load_dwordx4 v[164:167], v158, s[40:43], 0 offen sc1
    buffer_load_dwordx4 v[160:163], v157, s[40:43], 0 offen sc1
    s_waitcnt vmcnt(0)
    s_branch L_chk_1
L_ok_2:
    v_mov_b32 v168, v160
    v_mov_b32 v169, v161
    v_cmp_ne_u32 vcc, s53, v164
    v_permlane32_swap_b32 v160, v168
    v_permlane32_swap_b32 v161, v169
    s_cmp_eq_u64 vcc, 0
    s_cselect_b32 s54, 1, 0
    s_lshl_b32 s81, s54, 11
    s_sub_u32 s81, 2048, s81
    v_lshlrev_b32 v170, 16, v160
    v_and_b32 v171, 0xffff0000, v160
    v_lshlrev_b32 v172, 16, v161
    v_and_b32 v173, 0xffff0000, v161
    v_lshlrev_b32 v174, 16, v168
    v_and_b32 v175, 0xffff0000, v168
    v_lshlrev_b32 v176, 16, v169
    v_and_b32 v177, 0xffff0000, v169
    s_cmp_eq_u32 s54, 0
    s_cbranch_scc1 L_slow_3
    v_pk_fma_f32 v[106:107], v[106:107], v[174:175], v[170:171]
    v_pk_fma_f32 v[108:109], v[108:109], v[176:177], v[172:173]
    v_cvt_pk_bf16_f32 v96, v106, v107
    v_cvt_pk_bf16_f32 v97, v108, v109
    v_min_u32 v96, -2, v96
    buffer_store_dwordx2 v[96:97], v152, s[40:43], s34 offen
    v_pk_fma_f32 v[110:111], v[110:111], v[174:175], v[170:171]
    v_pk_fma_f32 v[112:113], v[112:113], v[176:177], v[172:173]
    v_cvt_pk_bf16_f32 v98, v110, v111
    v_cvt_pk_bf16_f32 v99, v112, v113
    v_min_u32 v98, -2, v98
    buffer_store_dwordx2 v[98:99], v153, s[40:43], s34 offen
    v_pk_fma_f32 v[114:115], v[114:115], v[174:175], v[170:171]
    v_pk_fma_f32 v[116:117], v[116:117], v[176:177], v[172:173]
    v_cvt_pk_bf16_f32 v100, v114, v115
    v_cvt_pk_bf16_f32 v101, v116, v117
    v_min_u32 v100, -2, v100
    buffer_store_dwordx2 v[100:101], v154, s[40:43], s34 offen
    v_pk_fma_f32 v[118:119], v[118:119], v[174:175], v[170:171]
    v_pk_fma_f32 v[120:121], v[120:121], v[176:177], v[172:173]
    v_cvt_pk_bf16_f32 v102, v118, v119
    v_cvt_pk_bf16_f32 v103, v120, v121
    v_min_u32 v102, -2, v102
    buffer_store_dwordx2 v[102:103], v155, s[40:43], s34 offen
    v_pk_fma_f32 v[122:123], v[122:123], v[174:175], v[170:171]
    v_pk_fma_f32 v[124:125], v[124:125], v[176:177], v[172:173]
    v_cvt_pk_bf16_f32 v104, v122, v123
    v_cvt_pk_bf16_f32 v105, v124, v125
    v_min_u32 v104, -2, v104
    buffer_store_dwordx2 v[104:105], v156, s[40:43], s34 offen
    s_mov_b32 s66, 0x4e20
L_chk_5:
    v_cmp_ne_u64 vcc, s[44:45], v[4:5]
    s_and_b64 vcc, vcc, s[82:83]
    s_cbranch_scc0 L_ok_6
    s_sub_u32 s66, s66, 1
    s_cbranch_scc1 L_ok_6
    buffer_load_dwordx2 v[4:5], v3, s[40:43], 0 offen offset:1536 sc1
    s_waitcnt vmcnt(0)
    s_branch L_chk_5
L_ok_6:
L_join_4:
    s_barrier
    buffer_load_dwordx4 v23, s[12:15], s67 offen offset:2048 lds
    s_lshl_b32 s58, s58, 14
    s_add_u32 s72, s72, s58
    s_add_u32 s72, s72, 524288
    v_lshrrev_b32 v36, 2, v1
    v_lshl_add_u32 v36, v36, 10, s57
    v_and_b32 v35, 0x30, v2
    v_add_u32 v151, v35, v36
    s_add_u32 m0, s68, 98304
    s_mov_b32 s67, 0x90000
    buffer_load_dwordx4 v23, s[12:15], s67 offen offset:0 lds
    s_bitcmp1_b32 s52, 3
    s_mov_b32 s55, 0x7654e210
    s_cselect_b32 s55, 0xb3dcfa98, s55
    s_lshl_b32 s77, s50, 2
    s_lshr_b32 s77, s55, s77
    buffer_load_dwordx4 v23, s[12:15], s67 offen offset:1024 lds
    s_and_b32 s77, s77, 15
    s_mul_i32 s55, s77, 12
    s_sub_u32 s56, 172, s55
    s_lshl_b32 s55, s55, 4
    s_mul_i32 s57, s46, 44032
    s_add_u32 s55, s55, s57
    v_mov_b32 v37, 0x40000000
    buffer_load_dwordx4 v23, s[12:15], s67 offen offset:2048 lds
    v_add_u32 v36, 0, v1
    v_mul_u32_u24 v35, 171, v36
    v_lshrrev_b32 v35, 11, v35
    v_mul_u32_u24 v32, 12, v35
    v_sub_u32 v36, v36, v32
    v_cmp_gt_i32 vcc, s56, v36
    v_mul_u32_u24 v35, 2752, v35
    v_lshl_add_u32 v36, v36, 4, s55
    v_add_u32 v36, v36, v35
    v_cndmask_b32 v252, v37, v36, vcc
    s_add_u32 m0, s68, 110592
    s_mov_b32 s67, 0xa8000
    buffer_load_dwordx4 v23, s[12:15], s67 offen offset:0 lds
    s_sub_u32 s55, s55, 1024
    v_add_u32 v36, 64, v1
    v_mul_u32_u24 v35, 171, v36
    v_lshrrev_b32 v35, 11, v35
    v_mul_u32_u24 v32, 12, v35
    v_sub_u32 v36, v36, v32
    v_cmp_gt_i32 vcc, s56, v36
    v_mul_u32_u24 v35, 2752, v35
    v_lshl_add_u32 v36, v36, 4, s55
    v_add_u32 v36, v36, v35
    v_cndmask_b32 v253, v37, v36, vcc
    s_sub_u32 s55, s55, 1024
    v_add_u32 v36, 128, v1
    v_mul_u32_u24 v35, 171, v36
    v_lshrrev_b32 v35, 11, v35
    v_mul_u32_u24 v32, 12, v35
    v_sub_u32 v36, v36, v32
    v_cmp_gt_i32 vcc, s56, v36
    v_mul_u32_u24 v35, 2752, v35
    v_lshl_add_u32 v36, v36, 4, s55
    v_add_u32 v36, v36, v35
    v_cndmask_b32 v254, v37, v36, vcc
    v_lshlrev_b32 v36, 4, v0
    v_add_u32 v248, 4096, v36
    s_mov_b32 s4, 0x1000
    s_mov_b32 s3, 0x2000
    v_lshlrev_b32 v36, 3, v0
    v_add_u32 v249, 159744, v36
    s_and_b32 s56, s48, 3
    s_lshl2_add_u32 s56, s47, s56
    s_and_b32 s55, s48, 28
    s_lshl_b32 s57, s56, 14
    s_add_u32 s57, s57, 12582912
    s_add_u32 s58, s55, s46
    s_lshl_b32 s58, s58, 9
    s_add_u32 m0, s33, 0
    s_add_u32 s67, s32, 0
    buffer_load_dwordx4 v2, s[40:43], s67 offen offset:0 sc1 lds
    buffer_load_dwordx4 v2, s[40:43], s67 offen offset:1024 sc1 lds
    buffer_load_dwordx4 v2, s[40:43], s67 offen offset:2048 sc1 lds
    buffer_load_dwordx4 v2, s[40:43], s67 offen offset:3072 sc1 lds
    s_add_u32 m0, s33, 4096
    s_add_u32 s67, s32, 4096
    buffer_load_dwordx4 v2, s[40:43], s67 offen offset:0 sc1 lds
    s_add_u32 m0, s68, 110592
    s_mov_b32 s67, 0xa8000
    buffer_load_dwordx4 v23, s[12:15], s67 offen offset:1024 lds
    s_add_u32 s58, s58, s57
    v_and_b32 v196, 15, v1
    v_and_b32 v197, 0x30, v1
    v_lshl_add_u32 v197, v196, 6, v197
    v_add_u32 v197, s58, v197
    v_mov_b32 v198, 0x40000000
    v_cmp_gt_u32 vcc, 8, v196
    s_lshl4_add_u32 s57, s55, s57
    v_lshrrev_b32 v196, 2, v0
    v_cndmask_b32 v210, v198, v197, vcc
    buffer_load_dwordx4 v23, s[12:15], s67 offen offset:2048 lds
    v_and_b32 v197, 0x30, v2
    v_lshl_add_u32 v197, v196, 9, v197
    v_add_u32 v197, s57, v197
    v_cmp_gt_u32 vcc, 64, v0
    s_lshl_b32 s56, s56, 5
    s_add_u32 s56, s56, s55
    v_cndmask_b32 v211, v198, v197, vcc
    s_add_u32 m0, s68, 122880
    s_mov_b32 s67, 0xc0000
    buffer_load_dwordx4 v23, s[12:15], s67 offen offset:0 lds
    s_lshl3_add_u32 s56, s56, 4096
    v_lshl_add_u32 v197, v0, 3, s56
    v_and_b32 v196, 0xfd, v0
    v_cmp_eq_u32 vcc, 0, v196
    s_lshr_b32 s55, s47, 1
    s_cmp_eq_u32 s55, 2
    s_cselect_b32 s79, 1.0, 0
    v_cndmask_b32 v212, v198, v197, vcc
    buffer_load_dwordx4 v23, s[12:15], s67 offen offset:1024 lds
    ds_read_b64_tr_b16 a[0:1], v14 offset:0
    ds_read_b64_tr_b16 a[2:3], v14 offset:512
    ds_read_b64_tr_b16 a[4:5], v14 offset:1024
    ds_read_b64_tr_b16 a[6:7], v14 offset:1536
    ds_read_b64_tr_b16 a[8:9], v14 offset:2048
    ds_read_b64_tr_b16 a[10:11], v14 offset:2560
    ds_read_b64_tr_b16 a[12:13], v14 offset:12288
    ds_read_b64_tr_b16 a[14:15], v14 offset:12800
    ds_read_b64_tr_b16 a[16:17], v14 offset:13312
    ds_read_b64_tr_b16 a[18:19], v14 offset:13824
    ds_read_b64_tr_b16 a[20:21], v14 offset:14336
    ds_read_b64_tr_b16 a[22:23], v14 offset:14848
    s_mov_b32 s55, 0x5040100
    s_mov_b32 s56, 0x7060302
    v_lshlrev_b32 v196, 16, v208
    v_and_b32 v197, 0xffff0000, v208
    v_mul_f32 v198, -1.4426950408889634, v196
    v_mul_f32 v199, -1.4426950408889634, v197
    v_exp_f32 v198, v198
    v_exp_f32 v199, v199
    v_add_f32 v198, 1.0, v198
    v_add_f32 v199, 1.0, v199
    v_rcp_f32 v198, v198
    v_rcp_f32 v199, v199
    v_mul_f32 v196, v196, v198
    v_mul_f32 v197, v197, v199
    v_cvt_pk_bf16_f32 v208, v196, v197
    v_perm_b32 v196, v192, v188, s55
    v_perm_b32 v197, v192, v188, s56
    v_dot2_f32_bf16 v200, v196, v208, 0
    v_dot2_f32_bf16 v201, v197, v208, 0
    v_perm_b32 v198, v193, v189, s55
    v_perm_b32 v199, v193, v189, s56
    v_dot2_f32_bf16 v202, v198, v208, 0
    v_dot2_f32_bf16 v203, v199, v208, 0
    v_perm_b32 v196, v194, v190, s55
    v_perm_b32 v197, v194, v190, s56
    v_dot2_f32_bf16 v204, v196, v208, 0
    v_dot2_f32_bf16 v205, v197, v208, 0
    v_perm_b32 v198, v195, v191, s55
    v_perm_b32 v199, v195, v191, s56
    v_dot2_f32_bf16 v206, v198, v208, 0
    v_dot2_f32_bf16 v207, v199, v208, 0
    v_permlane32_swap_b32 v200, v204
    v_permlane32_swap_b32 v201, v205
    v_permlane32_swap_b32 v202, v206
    v_permlane32_swap_b32 v203, v207
    v_add_f32 v200, v200, v204
    v_add_f32 v201, v201, v205
    v_add_f32 v202, v202, v206
    v_add_f32 v203, v203, v207
    s_nop 0
    v_permlane16_swap_b32 v200, v202
    v_permlane16_swap_b32 v201, v203
    v_add_f32 v200, v200, v202
    v_add_f32 v201, v201, v203
    v_mov_b32 v202, s44
    v_mov_b32 v203, s45
    v_add_f32_dpp v200, v200, v200 row_ror:8 row_mask:0xf bank_mask:0xf
    v_add_f32_dpp v201, v201, v201 row_ror:8 row_mask:0xf bank_mask:0xf
    buffer_store_dwordx4 v[200:203], v210, s[40:43], 0 offen sc1
    buffer_load_dwordx4 v23, s[12:15], s67 offen offset:2048 lds
    s_add_u32 m0, s68, 135168
    s_mov_b32 s67, 0xd8000
    buffer_load_dwordx4 v23, s[12:15], s67 offen offset:0 lds
    buffer_load_dwordx4 v23, s[12:15], s67 offen offset:1024 lds
    s_waitcnt vmcnt(8)
    ds_read_b128 v[160:163], v159 offset:0
    ds_read_b128 v[164:167], v159 offset:1024
    ds_read_b128 v[168:171], v159 offset:2048
    ds_read_b128 v[172:175], v159 offset:3072
    ds_read_b128 v[176:179], v159 offset:4096
    s_waitcnt lgkmcnt(3)
    v_max3_u32 v161, v160, v162, v164
    s_waitcnt lgkmcnt(2)
    v_max3_u32 v161, v161, v166, v168
    s_waitcnt lgkmcnt(1)
    v_max3_u32 v161, v161, v170, v172
    s_waitcnt lgkmcnt(0)
    v_max3_u32 v161, v161, v174, v176
    v_max_u32 v161, v161, v178
    v_cmp_eq_u32 vcc, -1, v161
    s_cmp_lg_u64 vcc, 0
    s_mov_b32 s66, 0x4e20
    s_cbranch_scc1 L_again_7
L_hok_8:
    s_barrier
    ds_read_b128 v[96:99], v10 offset:0
    ds_read_b128 v[100:103], v10 offset:4096
    ds_read_b128 v[104:107], v10 offset:8192
    ds_read_b128 v[108:111], v10 offset:12288
    ds_read_b128 v[112:115], v10 offset:16384
    s_waitcnt lgkmcnt(4)
    v_mfma_f32_16x16x32_bf16 v[40:43], a[4:7], v[96:99], 0
    s_add_u32 m0, s33, 20480
    s_add_u32 s67, s32, 20480
    v_mfma_f32_16x16x32_bf16 v[60:63], v[96:99], a[8:11], 0
    ds_read_b128 v[116:119], v11 offset:0
    ds_read_b64_tr_b16 a[24:25], v14 offset:24576
    s_waitcnt lgkmcnt(5)
    v_mfma_f32_16x16x32_bf16 v[44:47], a[4:7], v[100:103], 0
    ds_read_b64_tr_b16 a[26:27], v14 offset:25088
    ds_read_b64_tr_b16 a[28:29], v14 offset:25600
    v_mfma_f32_16x16x32_bf16 v[64:67], v[100:103], a[8:11], 0
    buffer_load_dwordx4 v2, s[40:43], s67 offen offset:0 sc1 lds
    v_mfma_f32_16x16x32_bf16 v[24:27], a[0:3], v[100:103], 0
    ds_read_b128 v[120:123], v11 offset:4096
    ds_read_b64_tr_b16 a[30:31], v14 offset:26112
    s_waitcnt lgkmcnt(8)
    v_mfma_f32_16x16x32_bf16 v[48:51], a[4:7], v[104:107], 0
    ds_read_b64_tr_b16 a[32:33], v14 offset:26624
    ds_read_b64_tr_b16 a[34:35], v14 offset:27136
    v_mfma_f32_16x16x32_bf16 v[68:71], v[104:107], a[8:11], 0
    ds_read_b128 v[124:127], v11 offset:8192
    v_mfma_f32_16x16x32_bf16 v[28:31], a[0:3], v[104:107], 0
    ds_read_b64_tr_b16 a[36:37], v14 offset:36864
    ds_read_b64_tr_b16 a[38:39], v14 offset:37376
    s_waitcnt lgkmcnt(12)
    v_mfma_f32_16x16x32_bf16 v[52:55], a[4:7], v[108:111], 0
    ds_read_b128 v[128:131], v11 offset:12288
    buffer_load_dwordx4 v2, s[40:43], s67 offen offset:1024 sc1 lds
    v_mfma_f32_16x16x32_bf16 v[72:75], v[108:111], a[8:11], 0
    ds_read_b64_tr_b16 a[40:41], v14 offset:37888
    ds_read_b64_tr_b16 a[42:43], v14 offset:38400
    v_mfma_f32_16x16x32_bf16 v[32:35], a[0:3], v[108:111], 0
    ds_read_b128 v[132:135], v11 offset:16384
    ds_read_b64_tr_b16 a[44:45], v14 offset:38912
    s_waitcnt lgkmcnt(15)
    v_mfma_f32_16x16x32_bf16 v[56:59], a[4:7], v[112:115], 0
    ds_read_b64_tr_b16 a[46:47], v14 offset:39424
    ds_read_b64_tr_b16 a[48:49], v14 offset:49152
    v_mfma_f32_16x16x32_bf16 v[76:79], v[112:115], a[8:11], 0
    ds_read_b64_tr_b16 a[50:51], v14 offset:49664
    buffer_load_dwordx4 v2, s[40:43], s67 offen offset:2048 sc1 lds
    buffer_load_dwordx4 v2, s[40:43], s67 offen offset:3072 sc1 lds
    v_mfma_f32_16x16x32_bf16 v[36:39], a[0:3], v[112:115], 0
    s_waitcnt lgkmcnt(4)
    v_mfma_f32_16x16x32_bf16 v[40:43], a[16:19], v[116:119], v[40:43]
    ds_read_b64_tr_b16 a[52:53], v14 offset:50176
    v_mfma_f32_16x16x32_bf16 v[60:63], v[116:119], a[20:23], v[60:63]
    ds_read_b64_tr_b16 a[54:55], v14 offset:50688
    ds_read_b64_tr_b16 a[56:57], v14 offset:51200
    v_mfma_f32_16x16x32_bf16 v[44:47], a[16:19], v[120:123], v[44:47]
    ds_read_b64_tr_b16 a[58:59], v14 offset:51712
    ds_read_b64_tr_b16 a[60:61], v14 offset:61440
    v_mfma_f32_16x16x32_bf16 v[64:67], v[120:123], a[20:23], v[64:67]
    ds_read_b64_tr_b16 a[62:63], v14 offset:61952
    ds_read_b64_tr_b16 a[64:65], v14 offset:62464
    v_mfma_f32_16x16x32_bf16 v[24:27], a[12:15], v[120:123], v[24:27]
    ds_read_b128 v[96:99], v12 offset:0
    ds_read_b64_tr_b16 a[66:67], v14 offset:62976
    v_mfma_f32_16x16x32_bf16 v[48:51], a[16:19], v[124:127], v[48:51]
    ds_read_b64_tr_b16 a[68:69], v14 offset:63488
    s_add_u32 m0, s33, 24576
    v_mfma_f32_16x16x32_bf16 v[68:71], v[124:127], a[20:23], v[68:71]
    ds_read_b64_tr_b16 a[70:71], v14 offset:64000
    s_add_u32 s67, s32, 24576
    v_mfma_f32_16x16x32_bf16 v[28:31], a[12:15], v[124:127], v[28:31]
    ds_read_b128 v[100:103], v12 offset:4096
    ds_read_b64_tr_b16 a[72:73], v15 offset:0
    v_mfma_f32_16x16x32_bf16 v[52:55], a[16:19], v[128:131], v[52:55]
    ds_read_b64_tr_b16 a[74:75], v15 offset:512
    ds_read_b128 v[104:107], v12 offset:8192
    v_mfma_f32_16x16x32_bf16 v[72:75], v[128:131], a[20:23], v[72:75]
    buffer_load_dwordx4 v2, s[40:43], s67 offen offset:0 sc1 lds
    ds_read_b128 v[108:111], v12 offset:12288
    v_mfma_f32_16x16x32_bf16 v[32:35], a[12:15], v[128:131], v[32:35]
    ds_read_b64_tr_b16 a[76:77], v15 offset:1024
    ds_read_b64_tr_b16 a[78:79], v15 offset:1536
    ds_read_b64_tr_b16 a[80:81], v15 offset:2048
    ds_read_b64_tr_b16 a[82:83], v15 offset:2560
    ds_read_b128 v[112:115], v12 offset:16384
    v_mfma_f32_16x16x32_bf16 v[56:59], a[16:19], v[132:135], v[56:59]
    v_mfma_f32_16x16x32_bf16 v[76:79], v[132:135], a[20:23], v[76:79]
    s_add_u32 m0, s69, 0
    s_mov_b32 s67, 0x0
    v_mfma_f32_16x16x32_bf16 v[36:39], a[12:15], v[132:135], v[36:39]
    s_waitcnt lgkmcnt(0)
    v_mfma_f32_16x16x32_bf16 v[40:43], a[28:31], v[96:99], v[40:43]
    buffer_load_dwordx4 v17, s[16:19], s67 offen lds
    ds_read_b128 v[116:119], v13 offset:0
    v_mfma_f32_16x16x32_bf16 v[60:63], v[96:99], a[32:35], v[60:63]
    ds_read_b128 v[120:123], v13 offset:4096
    v_mfma_f32_16x16x32_bf16 v[44:47], a[28:31], v[100:103], v[44:47]
    ds_read_b128 v[124:127], v13 offset:8192
    v_mfma_f32_16x16x32_bf16 v[64:67], v[100:103], a[32:35], v[64:67]
    buffer_load_dword a247, v19, s[24:27], 0 offen
    s_waitcnt vmcnt(2)
    v_mfma_f32_16x16x32_bf16 v[24:27], a[24:27], v[100:103], v[24:27]
    ds_read_b128 v[160:163], v159 offset:20480
    v_mfma_f32_16x16x32_bf16 v[48:51], a[28:31], v[104:107], v[48:51]
    ds_read_b128 v[128:131], v13 offset:12288
    v_mfma_f32_16x16x32_bf16 v[68:71], v[104:107], a[32:35], v[68:71]
    ds_read_b128 v[164:167], v159 offset:21504
    v_mfma_f32_16x16x32_bf16 v[28:31], a[24:27], v[104:107], v[28:31]
    ds_read_b128 v[168:171], v159 offset:22528
    v_mfma_f32_16x16x32_bf16 v[52:55], a[28:31], v[108:111], v[52:55]
    ds_read_b128 v[172:175], v159 offset:23552
    ds_read_b128 v[176:179], v159 offset:24576
    s_waitcnt lgkmcnt(3)
    v_max3_u32 v161, v160, v162, v164
    v_mfma_f32_16x16x32_bf16 v[72:75], v[108:111], a[32:35], v[72:75]
    s_waitcnt lgkmcnt(2)
    v_max3_u32 v161, v161, v166, v168
    s_waitcnt lgkmcnt(1)
    v_max3_u32 v161, v161, v170, v172
    v_mfma_f32_16x16x32_bf16 v[32:35], a[24:27], v[108:111], v[32:35]
    ds_read_b128 v[132:135], v13 offset:16384
    s_waitcnt lgkmcnt(1)
    v_max3_u32 v161, v161, v174, v176
    v_mfma_f32_16x16x32_bf16 v[56:59], a[28:31], v[112:115], v[56:59]
    v_max_u32 v161, v161, v178
    s_add_u32 m0, s33, 40960
    v_mfma_f32_16x16x32_bf16 v[76:79], v[112:115], a[32:35], v[76:79]
    s_add_u32 s67, s32, 88064
    v_mfma_f32_16x16x32_bf16 v[36:39], a[24:27], v[112:115], v[36:39]
    s_waitcnt lgkmcnt(0)
    v_cmp_eq_u32 vcc, -1, v161
    s_cmp_lg_u64 vcc, 0
    s_cbranch_scc1 L_again_9
L_hok_10:
    s_barrier
    v_mfma_f32_16x16x32_bf16 v[40:43], a[40:43], v[116:119], v[40:43]
    ds_read_b128 v[96:99], v10 offset:20480
    v_mfma_f32_16x16x32_bf16 v[60:63], v[116:119], a[44:47], v[60:63]
    ds_read_b64_tr_b16 a[84:85], v15 offset:12288
    ds_read_b64_tr_b16 a[86:87], v15 offset:12800
    v_mfma_f32_16x16x32_bf16 v[44:47], a[40:43], v[120:123], v[44:47]
    buffer_load_dwordx4 v2, s[40:43], s67 offen offset:0 sc1 lds
    v_mfma_f32_16x16x32_bf16 v[64:67], v[120:123], a[44:47], v[64:67]
    ds_read_b64_tr_b16 a[88:89], v15 offset:13312
    ds_read_b128 v[100:103], v10 offset:24576
    v_mfma_f32_16x16x32_bf16 v[24:27], a[36:39], v[120:123], v[24:27]
    ds_read_b64_tr_b16 a[90:91], v15 offset:13824
    v_add_u32 v159, 40960, v159
    v_mfma_f32_16x16x32_bf16 v[48:51], a[40:43], v[124:127], v[48:51]
    ds_read_b64_tr_b16 a[92:93], v15 offset:14336
    ds_read_b128 v[104:107], v10 offset:28672
    v_mfma_f32_16x16x32_bf16 v[68:71], v[124:127], a[44:47], v[68:71]
    ds_read_b64_tr_b16 a[94:95], v15 offset:14848
    ds_read_b64_tr_b16 a[96:97], v15 offset:24576
    v_mfma_f32_16x16x32_bf16 v[28:31], a[36:39], v[124:127], v[28:31]
    ds_read_b64_tr_b16 a[98:99], v15 offset:25088
    ds_read_b64_tr_b16 a[100:101], v15 offset:25600
    v_mfma_f32_16x16x32_bf16 v[52:55], a[40:43], v[128:131], v[52:55]
    ds_read_b128 v[108:111], v10 offset:32768
    v_mfma_f32_16x16x32_bf16 v[72:75], v[128:131], a[44:47], v[72:75]
    buffer_load_dwordx4 v2, s[40:43], s67 offen offset:1024 sc1 lds
    ds_read_b64_tr_b16 a[102:103], v15 offset:26112
    v_mfma_f32_16x16x32_bf16 v[32:35], a[36:39], v[128:131], v[32:35]
    ds_read_b128 v[112:115], v10 offset:36864
    ds_read_b64_tr_b16 a[104:105], v15 offset:26624
    v_mfma_f32_16x16x32_bf16 v[56:59], a[40:43], v[132:135], v[56:59]
    ds_read_b64_tr_b16 a[106:107], v15 offset:27136
    v_add_u32 v10, 40960, v10
    v_mfma_f32_16x16x32_bf16 v[76:79], v[132:135], a[44:47], v[76:79]
    buffer_load_dwordx4 v2, s[40:43], s67 offen offset:2048 sc1 lds
    v_mfma_f32_16x16x32_bf16 v[36:39], a[36:39], v[132:135], v[36:39]
    ds_read_b128 v[116:119], v11 offset:20480
    s_waitcnt lgkmcnt(3)
    v_mfma_f32_16x16x32_bf16 v[40:43], a[52:55], v[96:99], v[40:43]
    buffer_load_dwordx4 v2, s[40:43], s67 offen offset:3072 sc1 lds
    v_mfma_f32_16x16x32_bf16 v[60:63], v[96:99], a[56:59], v[60:63]
    s_add_u32 m0, s33, 45056
    s_add_u32 s67, s32, 92160
    v_mfma_f32_16x16x32_bf16 v[44:47], a[52:55], v[100:103], v[44:47]
    ds_read_b128 v[120:123], v11 offset:24576
    v_mfma_f32_16x16x32_bf16 v[64:67], v[100:103], a[56:59], v[64:67]
    buffer_load_dwordx4 v2, s[40:43], s67 offen offset:0 sc1 lds
    ds_read_b128 v[124:127], v11 offset:28672
    v_mfma_f32_16x16x32_bf16 v[24:27], a[48:51], v[100:103], v[24:27]
    ds_read_b128 v[128:131], v11 offset:32768
    v_mfma_f32_16x16x32_bf16 v[48:51], a[52:55], v[104:107], v[48:51]
    buffer_load_dword a247, v19, s[16:19], 0 offen
    ds_read_b128 v[132:135], v11 offset:36864
    v_mfma_f32_16x16x32_bf16 v[68:71], v[104:107], a[56:59], v[68:71]
    v_mfma_f32_16x16x32_bf16 v[28:31], a[48:51], v[104:107], v[28:31]
    s_add_u32 m0, s68, 135168
    s_mov_b32 s67, 0xd8000
    buffer_load_dwordx4 v23, s[12:15], s67 offen offset:2048 lds
    s_add_u32 m0, s68, 147456
    v_mfma_f32_16x16x32_bf16 v[52:55], a[52:55], v[108:111], v[52:55]
    s_mov_b32 s67, 0xf0000
    v_mfma_f32_16x16x32_bf16 v[72:75], v[108:111], a[56:59], v[72:75]
    v_add_u32 v11, 40960, v11
    v_mfma_f32_16x16x32_bf16 v[32:35], a[48:51], v[108:111], v[32:35]
    v_mfma_f32_16x16x32_bf16 v[56:59], a[52:55], v[112:115], v[56:59]
    buffer_load_dwordx4 v23, s[12:15], s67 offen offset:0 lds
    ds_read_b128 v[96:99], v12 offset:20480
    v_mfma_f32_16x16x32_bf16 v[76:79], v[112:115], a[56:59], v[76:79]
    v_mfma_f32_16x16x32_bf16 v[36:39], a[48:51], v[112:115], v[36:39]
    ds_read_b128 v[100:103], v12 offset:24576
    s_waitcnt lgkmcnt(2)
    v_mfma_f32_16x16x32_bf16 v[40:43], a[64:67], v[116:119], v[40:43]
    v_mfma_f32_16x16x32_bf16 v[60:63], v[116:119], a[68:71], v[60:63]
    buffer_load_dwordx4 v23, s[12:15], s67 offen offset:1024 lds
    ds_read_b128 v[104:107], v12 offset:28672
    v_mfma_f32_16x16x32_bf16 v[44:47], a[64:67], v[120:123], v[44:47]
    ds_read_b128 v[108:111], v12 offset:32768
    v_mfma_f32_16x16x32_bf16 v[64:67], v[120:123], a[68:71], v[64:67]
    v_mfma_f32_16x16x32_bf16 v[24:27], a[60:63], v[120:123], v[24:27]
    ds_read_b128 v[112:115], v12 offset:36864
    v_mfma_f32_16x16x32_bf16 v[48:51], a[64:67], v[124:127], v[48:51]
    buffer_load_dwordx4 v23, s[12:15], s67 offen offset:2048 lds
    s_add_u32 m0, s68, 98304
    v_mfma_f32_16x16x32_bf16 v[68:71], v[124:127], a[68:71], v[68:71]
    s_mov_b32 s67, 0x108000
    v_mfma_f32_16x16x32_bf16 v[28:31], a[60:63], v[124:127], v[28:31]
    v_mfma_f32_16x16x32_bf16 v[52:55], a[64:67], v[128:131], v[52:55]
    v_mfma_f32_16x16x32_bf16 v[72:75], v[128:131], a[68:71], v[72:75]
    buffer_load_dwordx4 v23, s[12:15], s67 offen offset:0 lds
    v_add_u32 v12, 40960, v12
    v_mfma_f32_16x16x32_bf16 v[32:35], a[60:63], v[128:131], v[32:35]
    v_mfma_f32_16x16x32_bf16 v[56:59], a[64:67], v[132:135], v[56:59]
    ds_read_b128 v[116:119], v13 offset:20480
    v_mfma_f32_16x16x32_bf16 v[76:79], v[132:135], a[68:71], v[76:79]
    v_mfma_f32_16x16x32_bf16 v[36:39], a[60:63], v[132:135], v[36:39]
    buffer_load_dwordx4 v23, s[12:15], s67 offen offset:1024 lds
    s_waitcnt lgkmcnt(1)
    v_mfma_f32_16x16x32_bf16 v[40:43], a[76:79], v[96:99], v[40:43]
    ds_read_b128 v[120:123], v13 offset:24576
    v_mfma_f32_16x16x32_bf16 v[60:63], v[96:99], a[80:83], v[60:63]
    ds_read_b128 v[124:127], v13 offset:28672
    v_mfma_f32_16x16x32_bf16 v[44:47], a[76:79], v[100:103], v[44:47]
    ds_read_b128 v[128:131], v13 offset:32768
    v_mfma_f32_16x16x32_bf16 v[64:67], v[100:103], a[80:83], v[64:67]
    buffer_load_dwordx4 v23, s[12:15], s67 offen offset:2048 lds
    s_waitcnt vmcnt(8)
    v_mfma_f32_16x16x32_bf16 v[24:27], a[72:75], v[100:103], v[24:27]
    ds_read_b128 v[160:163], v159 offset:0
    s_add_u32 m0, s33, 61440
    v_mfma_f32_16x16x32_bf16 v[48:51], a[76:79], v[104:107], v[48:51]
    ds_read_b128 v[164:167], v159 offset:1024
    s_add_u32 s67, s32, 108544
    v_mfma_f32_16x16x32_bf16 v[68:71], v[104:107], a[80:83], v[68:71]
    ds_read_b128 v[168:171], v159 offset:2048
    v_mfma_f32_16x16x32_bf16 v[28:31], a[72:75], v[104:107], v[28:31]
    ds_read_b128 v[172:175], v159 offset:3072
    buffer_load_dwordx4 v2, s[40:43], s67 offen offset:0 sc1 lds
    v_mfma_f32_16x16x32_bf16 v[52:55], a[76:79], v[108:111], v[52:55]
    ds_read_b128 v[176:179], v159 offset:4096
    s_waitcnt lgkmcnt(3)
    v_max3_u32 v161, v160, v162, v164
    v_mfma_f32_16x16x32_bf16 v[72:75], v[108:111], a[80:83], v[72:75]
    ds_read_b128 v[132:135], v13 offset:36864
    s_waitcnt lgkmcnt(3)
    v_max3_u32 v161, v161, v166, v168
    v_mfma_f32_16x16x32_bf16 v[32:35], a[72:75], v[108:111], v[32:35]
    v_add_u32 v13, 40960, v13
    s_waitcnt lgkmcnt(2)
    v_max3_u32 v161, v161, v170, v172
    v_mfma_f32_16x16x32_bf16 v[56:59], a[76:79], v[112:115], v[56:59]
    buffer_load_dwordx4 v2, s[40:43], s67 offen offset:1024 sc1 lds
    v_mfma_f32_16x16x32_bf16 v[76:79], v[112:115], a[80:83], v[76:79]
    s_waitcnt lgkmcnt(1)
    v_max3_u32 v161, v161, v174, v176
    v_max_u32 v161, v161, v178
    v_mfma_f32_16x16x32_bf16 v[36:39], a[72:75], v[112:115], v[36:39]
    s_waitcnt lgkmcnt(0)
    v_cmp_eq_u32 vcc, -1, v161
    s_cmp_lg_u64 vcc, 0
    s_cbranch_scc1 L_again_11
L_hok_12:
    s_waitcnt vmcnt(8)
    s_barrier
    v_mfma_f32_16x16x32_bf16 v[40:43], a[88:91], v[116:119], v[40:43]
    v_mfma_f32_16x16x32_bf16 v[60:63], v[116:119], a[92:95], v[60:63]
    ds_read_b128 v[96:99], v10 offset:0
    ds_read_b64_tr_b16 a[108:109], v15 offset:36864
    v_mfma_f32_16x16x32_bf16 v[44:47], a[88:91], v[120:123], v[44:47]
    ds_read_b64_tr_b16 a[110:111], v15 offset:37376
    ds_read_b64_tr_b16 a[112:113], v15 offset:37888
    v_mfma_f32_16x16x32_bf16 v[64:67], v[120:123], a[92:95], v[64:67]
    buffer_load_dwordx4 v2, s[40:43], s67 offen offset:2048 sc1 lds
    v_mfma_f32_16x16x32_bf16 v[24:27], a[84:87], v[120:123], v[24:27]
    ds_read_b128 v[100:103], v10 offset:4096
    ds_read_b64_tr_b16 a[114:115], v15 offset:38400
    v_mfma_f32_16x16x32_bf16 v[48:51], a[88:91], v[124:127], v[48:51]
    buffer_load_dwordx4 v[188:191], v211, s[40:43], 0 offen sc1
    v_mfma_f32_16x16x32_bf16 v[68:71], v[124:127], a[92:95], v[68:71]
    ds_read_b64_tr_b16 a[116:117], v15 offset:38912
    ds_read_b128 v[104:107], v10 offset:8192
    v_mfma_f32_16x16x32_bf16 v[28:31], a[84:87], v[124:127], v[28:31]
    ds_read_b64_tr_b16 a[118:119], v15 offset:39424
    v_mfma_f32_16x16x32_bf16 v[52:55], a[88:91], v[128:131], v[52:55]
    ds_read_b128 v[108:111], v10 offset:12288
    buffer_load_dwordx4 v2, s[40:43], s67 offen offset:3072 sc1 lds
    v_mfma_f32_16x16x32_bf16 v[72:75], v[128:131], a[92:95], v[72:75]
    ds_read_b128 v[112:115], v10 offset:16384
    s_add_u32 m0, s33, 65536
    v_mfma_f32_16x16x32_bf16 v[32:35], a[84:87], v[128:131], v[32:35]
    buffer_load_dwordx4 v[192:195], v211, s[40:43], s3 offen sc1
    v_mfma_f32_16x16x32_bf16 v[56:59], a[88:91], v[132:135], v[56:59]
    ds_read_b128 v[116:119], v11 offset:0
    s_add_u32 s67, s32, 112640
    v_mfma_f32_16x16x32_bf16 v[76:79], v[132:135], a[92:95], v[76:79]
    buffer_load_dwordx4 v2, s[40:43], s67 offen offset:0 sc1 lds
    v_mfma_f32_16x16x32_bf16 v[36:39], a[84:87], v[132:135], v[36:39]
    s_add_u32 m0, s68, 110592
    s_waitcnt lgkmcnt(1)
    v_mfma_f32_16x16x32_bf16 v[40:43], a[100:103], v[96:99], v[40:43]
    ds_read_b128 v[120:123], v11 offset:4096
    s_mov_b32 s67, 0x120000
    v_mfma_f32_16x16x32_bf16 v[60:63], v[96:99], a[104:107], v[60:63]
    buffer_load_dwordx4 v23, s[12:15], s67 offen offset:0 lds
    v_mfma_f32_16x16x32_bf16 v[44:47], a[100:103], v[100:103], v[44:47]
    ds_read_b128 v[124:127], v11 offset:8192
    v_mfma_f32_16x16x32_bf16 v[64:67], v[100:103], a[104:107], v[64:67]
    buffer_load_dwordx4 v23, s[12:15], s67 offen offset:1024 lds
    ds_read_b128 v[128:131], v11 offset:12288
    v_mfma_f32_16x16x32_bf16 v[24:27], a[96:99], v[100:103], v[24:27]
    ds_read_b128 v[132:135], v11 offset:16384
    v_mfma_f32_16x16x32_bf16 v[48:51], a[100:103], v[104:107], v[48:51]
    v_mfma_f32_16x16x32_bf16 v[68:71], v[104:107], a[104:107], v[68:71]
    v_mfma_f32_16x16x32_bf16 v[28:31], a[96:99], v[104:107], v[28:31]
    buffer_load_dwordx4 v23, s[12:15], s67 offen offset:2048 lds
    s_add_u32 m0, s68, 122880
    v_mfma_f32_16x16x32_bf16 v[52:55], a[100:103], v[108:111], v[52:55]
    s_mov_b32 s67, 0x138000
    v_mfma_f32_16x16x32_bf16 v[72:75], v[108:111], a[104:107], v[72:75]
    v_mfma_f32_16x16x32_bf16 v[32:35], a[96:99], v[108:111], v[32:35]
    v_mfma_f32_16x16x32_bf16 v[56:59], a[100:103], v[112:115], v[56:59]
    buffer_load_dwordx4 v23, s[12:15], s67 offen offset:0 lds
    ds_read_b128 v[96:99], v12 offset:0
    v_mfma_f32_16x16x32_bf16 v[76:79], v[112:115], a[104:107], v[76:79]
    v_mfma_f32_16x16x32_bf16 v[36:39], a[96:99], v[112:115], v[36:39]
    s_waitcnt lgkmcnt(1)
    s_waitcnt vmcnt(11)
    s_waitcnt lgkmcnt(0)
    s_barrier
    v_mfma_f32_16x16x32_bf16 v[40:43], a[112:115], v[116:119], v[40:43]
    ds_read_b64_tr_b16 a[120:121], v15 offset:49152
    ds_read_b64_tr_b16 a[122:123], v15 offset:49664
    ds_read_b64_tr_b16 a[124:125], v15 offset:50176
    v_mfma_f32_16x16x32_bf16 v[60:63], v[116:119], a[116:119], v[60:63]
    buffer_load_dwordx4 v23, s[12:15], s67 offen offset:1024 lds
    ds_read_b128 v[100:103], v12 offset:4096
    v_mfma_f32_16x16x32_bf16 v[44:47], a[112:115], v[120:123], v[44:47]
    ds_read_b64_tr_b16 a[126:127], v15 offset:50688
    ds_read_b64_tr_b16 a[128:129], v15 offset:51200
    ds_read_b64_tr_b16 a[130:131], v15 offset:51712
    v_mfma_f32_16x16x32_bf16 v[64:67], v[120:123], a[116:119], v[64:67]
    ds_read_b128 v[104:107], v12 offset:8192
    v_mfma_f32_16x16x32_bf16 v[24:27], a[108:111], v[120:123], v[24:27]
    ds_read_b64_tr_b16 a[132:133], v15 offset:0
    ds_read_b64_tr_b16 a[134:135], v15 offset:512
    ds_read_b64_tr_b16 a[136:137], v15 offset:1024
    v_mfma_f32_16x16x32_bf16 v[48:51], a[112:115], v[124:127], v[48:51]
    ds_read_b128 v[108:111], v12 offset:12288
    buffer_load_dwordx4 v23, s[12:15], s67 offen offset:2048 lds
    ds_read_b64_tr_b16 a[138:139], v15 offset:1536
    v_mfma_f32_16x16x32_bf16 v[68:71], v[124:127], a[116:119], v[68:71]
    ds_read_b128 v[112:115], v12 offset:16384
    s_add_u32 m0, s68, 135168
    s_mov_b32 s67, 0x150000
    v_mfma_f32_16x16x32_bf16 v[28:31], a[108:111], v[124:127], v[28:31]
    ds_read_b64_tr_b16 a[140:141], v15 offset:2048
    ds_read_b64_tr_b16 a[142:143], v15 offset:2560
    v_mfma_f32_16x16x32_bf16 v[52:55], a[112:115], v[128:131], v[52:55]
    v_mfma_f32_16x16x32_bf16 v[72:75], v[128:131], a[116:119], v[72:75]
    buffer_load_dwordx4 v23, s[12:15], s67 offen offset:0 lds
    v_mfma_f32_16x16x32_bf16 v[32:35], a[108:111], v[128:131], v[32:35]
    v_mfma_f32_16x16x32_bf16 v[56:59], a[112:115], v[132:135], v[56:59]
    ds_read_b128 v[116:119], v13 offset:0
    s_mov_b32 s66, 0x4e20
    s_waitcnt vmcnt(8)
    s_nop 3
L_chk_13:
    v_cmp_ne_u64 vcc, s[44:45], v[190:191]
    v_cmp_ne_u64 s[6:7], s[44:45], v[194:195]
    s_or_b64 vcc, vcc, s[6:7]
    s_cselect_b32 s6, 1, 0
    s_cmp_gt_u32 s6, s46
    s_cbranch_scc0 L_ok_14
    s_sub_u32 s66, s66, 1
    s_cbranch_scc1 L_ok_14
    buffer_load_dwordx4 v[188:191], v211, s[40:43], 0 offen sc1
    buffer_load_dwordx4 v[192:195], v211, s[40:43], s3 offen sc1
    s_waitcnt vmcnt(0)
    s_branch L_chk_13
L_ok_14:
    v_mfma_f32_16x16x32_bf16 v[76:79], v[132:135], a[116:119], v[76:79]
    v_add_f32 v188, v188, v192
    v_add_f32 v189, v189, v193
    v_mfma_f32_16x16x32_bf16 v[36:39], a[108:111], v[132:135], v[36:39]
    buffer_load_dwordx4 v23, s[12:15], s67 offen offset:1024 lds
    v_add_f32_dpp v188, v188, v188 row_ror:4 row_mask:0xf bank_mask:0xf
    s_waitcnt lgkmcnt(3)
    v_mfma_f32_16x16x32_bf16 v[40:43], a[124:127], v[96:99], v[40:43]
    ds_read_b128 v[120:123], v13 offset:4096
    v_add_f32_dpp v189, v189, v189 row_ror:4 row_mask:0xf bank_mask:0xf
    v_mfma_f32_16x16x32_bf16 v[60:63], v[96:99], a[128:131], v[60:63]
    ds_read_b128 v[124:127], v13 offset:8192
    v_mfma_f32_16x16x32_bf16 v[44:47], a[124:127], v[100:103], v[44:47]
    ds_read_b128 v[128:131], v13 offset:12288
    v_add_f32_dpp v188, v188, v188 row_ror:8 row_mask:0xf bank_mask:0xf
    v_mfma_f32_16x16x32_bf16 v[64:67], v[100:103], a[128:131], v[64:67]
    buffer_load_dwordx4 v23, s[12:15], s67 offen offset:2048 lds
    v_add_f32_dpp v189, v189, v189 row_ror:8 row_mask:0xf bank_mask:0xf
    s_waitcnt vmcnt(9)
    v_mfma_f32_16x16x32_bf16 v[24:27], a[120:123], v[100:103], v[24:27]
    ds_read_b128 v[160:163], v159 offset:20480
    v_mov_b32 v192, v188
    s_add_u32 m0, s69, 4096
    v_mfma_f32_16x16x32_bf16 v[48:51], a[124:127], v[104:107], v[48:51]
    s_bfm_b64 exec, 14, 0
    buffer_load_dword a247, v19, s[20:23], 0 offen
    s_mov_b64 exec, -1
    v_mfma_f32_16x16x32_bf16 v[68:71], v[104:107], a[128:131], v[68:71]
    ds_read_b128 v[164:167], v159 offset:21504
    s_mov_b32 s67, 0x8000
    v_mov_b32 v193, v189
    v_mfma_f32_16x16x32_bf16 v[28:31], a[120:123], v[104:107], v[28:31]
    s_mov_b32 exec_lo, 0x0
    s_mov_b32 exec_hi, 0x1000
    buffer_load_dword a247, v18, s[40:43], 0 offen
    s_mov_b64 exec, -1
    v_mfma_f32_16x16x32_bf16 v[52:55], a[124:127], v[108:111], v[52:55]
    ds_read_b128 v[168:171], v159 offset:22528
    ds_read_b128 v[172:175], v159 offset:23552
    ds_read_b128 v[176:179], v159 offset:24576
    v_mfma_f32_16x16x32_bf16 v[72:75], v[108:111], a[128:131], v[72:75]
    s_add_u32 s78, s78, 8200
    v_lshlrev_b32 v16, 24, v0
    buffer_store_dwordx2 v[8:9], v16, s[40:43], s78 offen sc1
    v_mfma_f32_16x16x32_bf16 v[32:35], a[120:123], v[108:111], v[32:35]
    ds_read_b128 v[132:135], v13 offset:16384
    v_mfma_f32_16x16x32_bf16 v[56:59], a[124:127], v[112:115], v[56:59]
    buffer_load_dwordx4 v17, s[16:19], s67 offen lds
    s_waitcnt lgkmcnt(4)
    v_max3_u32 v161, v160, v162, v164
    v_mfma_f32_16x16x32_bf16 v[76:79], v[112:115], a[128:131], v[76:79]
    v_permlane16_swap_b32 v188, v192
    s_waitcnt lgkmcnt(3)
    v_max3_u32 v161, v161, v166, v168
    s_waitcnt lgkmcnt(2)
    v_max3_u32 v161, v161, v170, v172
    s_waitcnt lgkmcnt(1)
    v_max3_u32 v161, v161, v174, v176
    v_max_u32 v161, v161, v178
    v_mfma_f32_16x16x32_bf16 v[36:39], a[120:123], v[112:115], v[36:39]
    s_waitcnt lgkmcnt(0)
    v_cmp_eq_u32 vcc, -1, v161
    s_cmp_lg_u64 vcc, 0
    s_cbranch_scc1 L_again_15
L_hok_16:
    s_waitcnt vmcnt(7)
    s_barrier
    v_mfma_f32_16x16x32_bf16 v[40:43], a[136:139], v[116:119], v[40:43]
    s_add_u32 m0, s68, 147456
    v_mfma_f32_16x16x32_bf16 v[60:63], v[116:119], a[140:143], v[60:63]
    v_permlane16_swap_b32 v189, v193
    v_add_f32 v188, v188, v192
    v_mfma_f32_16x16x32_bf16 v[44:47], a[136:139], v[120:123], v[44:47]
    ds_read_b128 v[96:99], v10 offset:20480
    s_mov_b32 s67, 0x168000
    v_add_f32 v189, v189, v193
    v_mfma_f32_16x16x32_bf16 v[64:67], v[120:123], a[140:143], v[64:67]
    ds_read_b64_tr_b16 a[144:145], v15 offset:12288
    ds_read_b64_tr_b16 a[146:147], v15 offset:12800
    v_mov_b32 v192, v188
    v_mfma_f32_16x16x32_bf16 v[24:27], a[132:135], v[120:123], v[24:27]
    buffer_load_dwordx4 v23, s[12:15], s67 offen offset:0 lds
    ds_read_b64_tr_b16 a[148:149], v15 offset:13312
    v_mfma_f32_16x16x32_bf16 v[48:51], a[136:139], v[124:127], v[48:51]
    ds_read_b128 v[100:103], v10 offset:24576
    ds_read_b64_tr_b16 a[150:151], v15 offset:13824
    v_mov_b32 v193, v189
    v_mfma_f32_16x16x32_bf16 v[68:71], v[124:127], a[140:143], v[68:71]
    ds_read_b64_tr_b16 a[152:153], v15 offset:14336
    ds_read_b128 v[104:107], v10 offset:28672
    v_permlane32_swap_b32 v188, v192
    v_mfma_f32_16x16x32_bf16 v[28:31], a[132:135], v[124:127], v[28:31]
    ds_read_b64_tr_b16 a[154:155], v15 offset:14848
    ds_read_b64_tr_b16 a[156:157], v15 offset:24576
    v_mfma_f32_16x16x32_bf16 v[52:55], a[136:139], v[128:131], v[52:55]
    ds_read_b64_tr_b16 a[158:159], v15 offset:25088
    ds_read_b128 v[108:111], v10 offset:32768
    v_permlane32_swap_b32 v189, v193
    v_mfma_f32_16x16x32_bf16 v[72:75], v[128:131], a[140:143], v[72:75]
    buffer_load_dwordx4 v23, s[12:15], s67 offen offset:1024 lds
    ds_read_b64_tr_b16 a[160:161], v15 offset:25600
    v_mfma_f32_16x16x32_bf16 v[32:35], a[132:135], v[128:131], v[32:35]
    ds_read_b64_tr_b16 a[162:163], v15 offset:26112
    ds_read_b128 v[112:115], v10 offset:36864
    v_add_f32 v188, v188, v192
    v_mfma_f32_16x16x32_bf16 v[56:59], a[136:139], v[132:135], v[56:59]
    ds_read_b64_tr_b16 a[164:165], v15 offset:26624
    ds_read_b64_tr_b16 a[166:167], v15 offset:27136
    v_add_f32 v189, v189, v193
    v_mfma_f32_16x16x32_bf16 v[76:79], v[132:135], a[140:143], v[76:79]
    buffer_load_dwordx4 v23, s[12:15], s67 offen offset:2048 lds
    v_cvt_pk_bf16_f32 v192, v188, v189
    v_mfma_f32_16x16x32_bf16 v[36:39], a[132:135], v[132:135], v[36:39]
    v_lshlrev_b32 v188, 16, v192
    s_add_u32 m0, s69, 8192
    s_waitcnt lgkmcnt(2)
    v_mfma_f32_16x16x32_bf16 v[40:43], a[148:151], v[96:99], v[40:43]
    s_mov_b32 s67, 0x10000
    v_and_b32 v189, 0xffff0000, v192
    v_add_f32 v188, s79, v188
    v_mfma_f32_16x16x32_bf16 v[60:63], v[96:99], a[152:155], v[60:63]
    buffer_load_dwordx4 v17, s[16:19], s67 offen lds
    ds_read_b128 v[116:119], v11 offset:20480
    v_mfma_f32_16x16x32_bf16 v[44:47], a[148:151], v[100:103], v[44:47]
    v_add_f32 v189, s79, v189
    s_add_u32 m0, s69, 12288
    s_mov_b32 s67, 0x18000
    v_mfma_f32_16x16x32_bf16 v[64:67], v[100:103], a[152:155], v[64:67]
    ds_read_b128 v[120:123], v11 offset:24576
    v_cvt_pk_bf16_f32 v200, v188, v189
    s_nop 1
    v_mov_b32_dpp v201, v200 quad_perm:[1,1,3,3] row_mask:0xf bank_mask:0xf
    v_mfma_f32_16x16x32_bf16 v[24:27], a[144:147], v[100:103], v[24:27]
    buffer_load_dwordx4 v17, s[16:19], s67 offen lds
    ds_read_b128 v[124:127], v11 offset:28672
    v_mfma_f32_16x16x32_bf16 v[48:51], a[148:151], v[104:107], v[48:51]
    ds_read_b128 v[128:131], v11 offset:32768
    s_add_u32 m0, s69, 16384
    s_mov_b32 s67, 0x20000
    v_mfma_f32_16x16x32_bf16 v[68:71], v[104:107], a[152:155], v[68:71]
    buffer_load_dwordx4 v[88:91], v151, s[8:11], 0 offen offset:0
    ds_read_b128 v[132:135], v11 offset:36864
    v_mfma_f32_16x16x32_bf16 v[28:31], a[144:147], v[104:107], v[28:31]
    v_mfma_f32_16x16x32_bf16 v[52:55], a[148:151], v[108:111], v[52:55]
    buffer_store_dwordx4 v[200:203], v212, s[40:43], 0 offen sc1
    v_mfma_f32_16x16x32_bf16 v[72:75], v[108:111], a[152:155], v[72:75]
    v_mfma_f32_16x16x32_bf16 v[32:35], a[144:147], v[108:111], v[32:35]
    buffer_load_dwordx4 v[92:95], v151, s[8:11], 0 offen offset:64
    v_mfma_f32_16x16x32_bf16 v[56:59], a[148:151], v[112:115], v[56:59]
    ds_read_b128 v[96:99], v12 offset:20480
    v_mfma_f32_16x16x32_bf16 v[76:79], v[112:115], a[152:155], v[76:79]
    buffer_load_dwordx4 v17, s[16:19], s67 offen lds
    s_add_u32 m0, s69, 20480
    s_mov_b32 s67, 0x28000
    buffer_load_dwordx4 v17, s[16:19], s67 offen lds
    s_add_u32 m0, s69, 24576
    s_mov_b32 s67, 0x30000
    buffer_load_dwordx4 v17, s[16:19], s67 offen lds
    s_add_u32 m0, s69, 28672
    s_mov_b32 s67, 0x38000
    buffer_load_dwordx4 v17, s[16:19], s67 offen lds
    v_mfma_f32_16x16x32_bf16 v[36:39], a[144:147], v[112:115], v[36:39]
    s_waitcnt lgkmcnt(1)
    s_waitcnt vmcnt(9)
    s_waitcnt lgkmcnt(0)
    s_barrier
    v_mfma_f32_16x16x32_bf16 v[40:43], a[160:163], v[116:119], v[40:43]
    v_mfma_f32_16x16x32_bf16 v[60:63], v[116:119], a[164:167], v[60:63]
    s_add_u32 m0, s69, 32768
    s_mov_b32 s67, 0x40000
    v_mfma_f32_16x16x32_bf16 v[44:47], a[160:163], v[120:123], v[44:47]
    ds_read_b64_tr_b16 a[168:169], v15 offset:36864
    ds_read_b64_tr_b16 a[170:171], v15 offset:37376
    ds_read_b64_tr_b16 a[172:173], v15 offset:37888
    v_mfma_f32_16x16x32_bf16 v[64:67], v[120:123], a[164:167], v[64:67]
    buffer_load_dwordx4 v17, s[16:19], s67 offen lds
    v_mfma_f32_16x16x32_bf16 v[24:27], a[156:159], v[120:123], v[24:27]
    ds_read_b128 v[100:103], v12 offset:24576
    s_add_u32 m0, s69, 36864
    s_mov_b32 s67, 0x48000
    v_mfma_f32_16x16x32_bf16 v[48:51], a[160:163], v[124:127], v[48:51]
    ds_read_b64_tr_b16 a[174:175], v15 offset:38400
    ds_read_b64_tr_b16 a[176:177], v15 offset:38912
    v_mfma_f32_16x16x32_bf16 v[68:71], v[124:127], a[164:167], v[68:71]
    ds_read_b128 v[104:107], v12 offset:28672
    ds_read_b64_tr_b16 a[178:179], v15 offset:39424
    v_mfma_f32_16x16x32_bf16 v[28:31], a[156:159], v[124:127], v[28:31]
    buffer_load_dwordx4 v17, s[16:19], s67 offen lds
    ds_read_b64_tr_b16 a[180:181], v15 offset:49152
    v_mfma_f32_16x16x32_bf16 v[52:55], a[160:163], v[128:131], v[52:55]
    s_add_u32 m0, s69, 40960
    s_mov_b32 s67, 0x50000
    v_mfma_f32_16x16x32_bf16 v[72:75], v[128:131], a[164:167], v[72:75]
    ds_read_b64_tr_b16 a[182:183], v15 offset:49664
    ds_read_b128 v[108:111], v12 offset:32768
    v_mfma_f32_16x16x32_bf16 v[32:35], a[156:159], v[128:131], v[32:35]
    ds_read_b64_tr_b16 a[184:185], v15 offset:50176
    ds_read_b64_tr_b16 a[186:187], v15 offset:50688
    ds_read_b128 v[112:115], v12 offset:36864
    v_mfma_f32_16x16x32_bf16 v[56:59], a[160:163], v[132:135], v[56:59]
    buffer_load_dwordx4 v17, s[16:19], s67 offen lds
    v_mfma_f32_16x16x32_bf16 v[76:79], v[132:135], a[164:167], v[76:79]
    ds_read_b64_tr_b16 a[188:189], v15 offset:51200
    ds_read_b64_tr_b16 a[190:191], v15 offset:51712
    s_add_u32 m0, s69, 45056
    v_mfma_f32_16x16x32_bf16 v[36:39], a[156:159], v[132:135], v[36:39]
    s_waitcnt lgkmcnt(2)
    v_mfma_f32_16x16x32_bf16 v[40:43], a[172:175], v[96:99], v[40:43]
    ds_read_b128 v[116:119], v13 offset:20480
    s_mov_b32 s67, 0x58000
    v_mfma_f32_16x16x32_bf16 v[60:63], v[96:99], a[176:179], v[60:63]
    buffer_load_dwordx4 v17, s[16:19], s67 offen lds
    v_mfma_f32_16x16x32_bf16 v[44:47], a[172:175], v[100:103], v[44:47]
    s_add_u32 m0, s69, 49152
    s_mov_b32 s67, 0x60000
    v_mfma_f32_16x16x32_bf16 v[64:67], v[100:103], a[176:179], v[64:67]
    buffer_load_dwordx4 v17, s[16:19], s67 offen lds
    v_mfma_f32_16x16x32_bf16 v[24:27], a[168:171], v[100:103], v[24:27]
    s_add_u32 m0, s69, 53248
    s_mov_b32 s67, 0x68000
    v_mfma_f32_16x16x32_bf16 v[48:51], a[172:175], v[104:107], v[48:51]
    buffer_load_dwordx4 v17, s[16:19], s67 offen lds
    v_mfma_f32_16x16x32_bf16 v[68:71], v[104:107], a[176:179], v[68:71]
    s_add_u32 m0, s69, 57344
    s_mov_b32 s67, 0x70000
    v_mfma_f32_16x16x32_bf16 v[28:31], a[168:171], v[104:107], v[28:31]
    ds_read_b128 v[120:123], v13 offset:24576
    v_mfma_f32_16x16x32_bf16 v[52:55], a[172:175], v[108:111], v[52:55]
    buffer_load_dwordx4 v17, s[16:19], s67 offen lds
    ds_read_b128 v[124:127], v13 offset:28672
    s_add_u32 m0, s69, 61440
    v_mfma_f32_16x16x32_bf16 v[72:75], v[108:111], a[176:179], v[72:75]
    ds_read_b128 v[128:131], v13 offset:32768
    s_mov_b32 s67, 0x78000
    v_mfma_f32_16x16x32_bf16 v[32:35], a[168:171], v[108:111], v[32:35]
    ds_read_b128 v[132:135], v13 offset:36864
    v_mfma_f32_16x16x32_bf16 v[56:59], a[172:175], v[112:115], v[56:59]
    buffer_load_dwordx4 v17, s[16:19], s67 offen lds
    v_mfma_f32_16x16x32_bf16 v[76:79], v[112:115], a[176:179], v[76:79]
    s_add_u32 m0, s68, 90112
    s_mov_b32 s67, 0x0
    buffer_load_dwordx4 v20, s[24:27], s67 offen offset:0 lds
    s_mov_b32 s67, 0x1c00
    buffer_load_dwordx4 v20, s[24:27], s67 offen offset:1024 lds
    s_mov_b32 s67, 0x3800
    buffer_load_dwordx4 v20, s[24:27], s67 offen offset:2048 lds
    v_mfma_f32_16x16x32_bf16 v[36:39], a[168:171], v[112:115], v[36:39]
    s_waitcnt lgkmcnt(0)
    s_barrier
    v_mfma_f32_16x16x32_bf16 v[40:43], a[184:187], v[116:119], v[40:43]
    v_mfma_f32_16x16x32_bf16 v[60:63], v[116:119], a[188:191], v[60:63]
    s_add_u32 m0, s68, 102400
    s_mov_b32 s67, 0x6000
    v_mfma_f32_16x16x32_bf16 v[44:47], a[184:187], v[120:123], v[44:47]
    buffer_load_dwordx4 v20, s[24:27], s67 offen offset:0 lds
    v_mfma_f32_16x16x32_bf16 v[64:67], v[120:123], a[188:191], v[64:67]
    s_mov_b32 s67, 0x7c00
    v_mfma_f32_16x16x32_bf16 v[24:27], a[180:183], v[120:123], v[24:27]
    buffer_load_dwordx4 v20, s[24:27], s67 offen offset:1024 lds
    s_mov_b32 s67, 0x9800
    v_mfma_f32_16x16x32_bf16 v[48:51], a[184:187], v[124:127], v[48:51]
    v_mfma_f32_16x16x32_bf16 v[68:71], v[124:127], a[188:191], v[68:71]
    buffer_load_dwordx4 v20, s[24:27], s67 offen offset:2048 lds
    s_add_u32 m0, s68, 114688
    v_mfma_f32_16x16x32_bf16 v[28:31], a[180:183], v[124:127], v[28:31]
    s_mov_b32 s67, 0xc000
    v_mfma_f32_16x16x32_bf16 v[52:55], a[184:187], v[128:131], v[52:55]
    v_mfma_f32_16x16x32_bf16 v[72:75], v[128:131], a[188:191], v[72:75]
    buffer_load_dwordx4 v20, s[24:27], s67 offen offset:0 lds
    s_mov_b32 s67, 0xdc00
    v_mfma_f32_16x16x32_bf16 v[32:35], a[180:183], v[128:131], v[32:35]
    v_mfma_f32_16x16x32_bf16 v[56:59], a[184:187], v[132:135], v[56:59]
    buffer_load_dwordx4 v20, s[24:27], s67 offen offset:1024 lds
    v_mfma_f32_16x16x32_bf16 v[76:79], v[132:135], a[188:191], v[76:79]
    v_mfma_f32_16x16x32_bf16 v[36:39], a[180:183], v[132:135], v[36:39]
    s_mov_b32 s67, 0xf800
    buffer_load_dwordx4 v20, s[24:27], s67 offen offset:2048 lds
    v_cvt_pk_bf16_f32 v144, v40, v41
    v_cvt_pk_bf16_f32 v145, v42, v43
    v_cvt_pk_bf16_f32 v146, v44, v45
    v_cvt_pk_bf16_f32 v147, v46, v47
    v_cvt_pk_bf16_f32 v136, v24, v25
    v_cvt_pk_bf16_f32 v137, v26, v27
    v_cvt_pk_bf16_f32 v148, v48, v49
    v_cvt_pk_bf16_f32 v149, v50, v51
    v_cvt_pk_bf16_f32 v138, v28, v29
    v_cvt_pk_bf16_f32 v139, v30, v31
    v_cvt_pk_bf16_f32 v150, v52, v53
    v_cvt_pk_bf16_f32 v151, v54, v55
    v_cvt_pk_bf16_f32 v140, v32, v33
    v_cvt_pk_bf16_f32 v141, v34, v35
    s_add_u32 m0, s68, 126976
    s_mov_b32 s67, 0x12000
    buffer_load_dwordx4 v20, s[24:27], s67 offen offset:0 lds
    v_cvt_pk_bf16_f32 v152, v56, v57
    v_cvt_pk_bf16_f32 v153, v58, v59
    v_cvt_pk_bf16_f32 v142, v36, v37
    v_cvt_pk_bf16_f32 v143, v38, v39
    v_mfma_f32_16x16x16_bf16 v[164:167], v[146:147], v[136:137], 0
    v_cvt_pk_bf16_f32 v154, v60, v61
    v_cvt_pk_bf16_f32 v155, v62, v63
    v_mfma_f32_16x16x16_bf16 v[180:183], v[144:145], v[136:137], v[224:227]
    v_cvt_pk_bf16_f32 v156, v64, v65
    v_cvt_pk_bf16_f32 v157, v66, v67
    v_mfma_f32_16x16x16_bf16 v[168:171], v[148:149], v[138:139], 0
    s_mov_b32 s67, 0x13c00
    buffer_load_dwordx4 v20, s[24:27], s67 offen offset:1024 lds
    v_mfma_f32_16x16x16_bf16 v[184:187], v[146:147], v[138:139], 0
    v_cvt_pk_bf16_f32 v158, v68, v69
    v_cvt_pk_bf16_f32 v159, v70, v71
    v_mfma_f32_16x16x16_bf16 v[172:175], v[150:151], v[140:141], 0
    v_mfma_f32_16x16x16_bf16 v[188:191], v[148:149], v[140:141], 0
    v_cvt_pk_bf16_f32 v160, v72, v73
    v_cvt_pk_bf16_f32 v161, v74, v75
    v_mfma_f32_16x16x16_bf16 v[176:179], v[152:153], v[142:143], 0
    v_mfma_f32_16x16x16_bf16 v[192:195], v[150:151], v[142:143], 0
    s_mov_b32 s67, 0x15800
    buffer_load_dwordx4 v20, s[24:27], s67 offen offset:2048 lds
    v_cvt_pk_bf16_f32 v162, v76, v77
    v_cvt_pk_bf16_f32 v163, v78, v79
    v_cndmask_b32 v164, v164, v165, s[60:61]
    v_cndmask_b32 v180, v180, v181, s[60:61]
    v_cndmask_b32 v196, v180, v164, s[62:63]
    v_cndmask_b32 v166, v166, v167, s[60:61]
    v_cndmask_b32 v182, v182, v183, s[60:61]
    v_cndmask_b32 v197, v182, v166, s[64:65]
    v_max_f32 v204, v196, v197
    v_cndmask_b32 v168, v168, v169, s[60:61]
    v_cndmask_b32 v184, v184, v185, s[60:61]
    v_cndmask_b32 v198, v184, v168, s[62:63]
    v_cndmask_b32 v170, v170, v171, s[60:61]
    v_cndmask_b32 v186, v186, v187, s[60:61]
    s_add_u32 m0, s68, 139264
    s_mov_b32 s67, 0x18000
    buffer_load_dwordx4 v20, s[24:27], s67 offen offset:0 lds
    v_cndmask_b32 v199, v186, v170, s[64:65]
    v_max_f32 v205, v198, v199
    v_cndmask_b32 v172, v172, v173, s[60:61]
    v_cndmask_b32 v188, v188, v189, s[60:61]
    v_cndmask_b32 v200, v188, v172, s[62:63]
    v_cndmask_b32 v174, v174, v175, s[60:61]
    v_cndmask_b32 v190, v190, v191, s[60:61]
    v_cndmask_b32 v201, v190, v174, s[64:65]
    v_max_f32 v206, v200, v201
    v_cndmask_b32 v176, v176, v177, s[60:61]
    v_cndmask_b32 v192, v192, v193, s[60:61]
    v_cndmask_b32 v202, v192, v176, s[62:63]
    v_cndmask_b32 v178, v178, v179, s[60:61]
    s_mov_b32 s67, 0x19c00
    buffer_load_dwordx4 v20, s[24:27], s67 offen offset:1024 lds
    v_cndmask_b32 v194, v194, v195, s[60:61]
    v_cndmask_b32 v203, v194, v178, s[64:65]
    v_max_f32 v207, v202, v203
    v_permlane16_swap_b32 v204, v205
    s_nop 0
    v_permlane16_swap_b32 v206, v207
    v_max_f32 v204, v204, v205
    v_max_f32 v206, v206, v207
    s_nop 1
    v_permlane32_swap_b32 v204, v206
    v_max_f32 v204, v204, v206
    v_mul_f32 v206, 0xbeb8aa3b, v204
    v_mul_f32 v204, 0xbeb8aa3b, v204
    s_mov_b32 s67, 0x1b800
    buffer_load_dwordx4 v20, s[24:27], s67 offen offset:2048 lds
    v_permlane32_swap_b32 v204, v206
    v_mov_b32 v205, v204
    v_mov_b32 v207, v206
    s_nop 0
    v_permlane16_swap_b32 v204, v205
    v_permlane16_swap_b32 v206, v207
    v_fma_f32 v196, v196, s80, v204
    v_fma_f32 v197, v197, s80, v204
    v_fma_f32 v198, v198, s80, v205
    v_fma_f32 v199, v199, s80, v205
    v_fma_f32 v200, v200, s80, v206
    v_fma_f32 v201, v201, s80, v206
    s_add_u32 m0, s68, 77824
    s_mov_b32 s67, 0x1e000
    buffer_load_dwordx4 v20, s[24:27], s67 offen offset:0 lds
    v_fma_f32 v202, v202, s80, v207
    v_fma_f32 v203, v203, s80, v207
    v_exp_f32 v196, v196
    v_exp_f32 v197, v197
    v_exp_f32 v198, v198
    v_exp_f32 v199, v199
    v_exp_f32 v200, v200
    v_exp_f32 v201, v201
    buffer_load_dwordx4 v[80:83], v248, s[40:43], 0 offen sc1
    buffer_load_dwordx4 v[84:87], v248, s[40:43], s4 offen sc1
    v_exp_f32 v202, v202
    v_exp_f32 v203, v203
    v_cvt_pk_bf16_f32 v196, v196, v196
    v_cvt_pk_bf16_f32 v197, v197, v197
    v_and_b32 v164, v216, v196
    v_and_b32 v165, v217, v197
    v_and_b32 v166, v218, v196
    v_and_b32 v167, v219, v197
    v_cvt_pk_bf16_f32 v198, v198, v198
    v_cvt_pk_bf16_f32 v199, v199, v199
    v_mfma_f32_16x16x32_bf16 v[228:231], a[192:195], v[164:167], 0
    v_and_b32 v168, v216, v198
    v_and_b32 v169, v217, v199
    v_mfma_f32_16x16x32_bf16 v[180:183], v[154:157], v[164:167], 0
    v_and_b32 v170, v218, v198
    v_and_b32 v171, v219, v199
    v_cvt_pk_bf16_f32 v200, v200, v200
    v_cvt_pk_bf16_f32 v201, v201, v201
    v_mfma_f32_16x16x32_bf16 v[232:235], a[192:195], v[168:171], 0
    v_and_b32 v172, v216, v200
    v_and_b32 v173, v217, v201
    v_mfma_f32_16x16x32_bf16 v[184:187], v[156:159], v[168:171], 0
    v_and_b32 v174, v218, v200
    v_and_b32 v175, v219, v201
    v_cvt_pk_bf16_f32 v202, v202, v202
    v_cvt_pk_bf16_f32 v203, v203, v203
    v_mfma_f32_16x16x32_bf16 v[236:239], a[192:195], v[172:175], 0
    v_and_b32 v176, v216, v202
    v_and_b32 v177, v217, v203
    v_mfma_f32_16x16x32_bf16 v[188:191], v[158:161], v[172:175], 0
    v_and_b32 v178, v218, v202
    v_and_b32 v179, v219, v203
    v_rcp_f32 v228, v228
    s_nop 0
    v_mul_f32 v180, v180, v228
    v_mfma_f32_16x16x32_bf16 v[240:243], a[192:195], v[176:179], 0
    v_mul_f32 v181, v181, v228
    v_mul_f32 v182, v182, v228
    v_mfma_f32_16x16x32_bf16 v[192:195], v[160:163], v[176:179], 0
    v_mul_f32 v183, v183, v228
    v_cvt_pk_bf16_f32 v208, v180, v181
    v_cvt_pk_bf16_f32 v209, v182, v183
    v_rcp_f32 v232, v232
    s_nop 0
    v_mul_f32 v184, v184, v232
    v_mul_f32 v185, v185, v232
    v_mul_f32 v186, v186, v232
    v_mul_f32 v187, v187, v232
    v_cvt_pk_bf16_f32 v210, v184, v185
    v_cvt_pk_bf16_f32 v211, v186, v187
    s_nop 0
    v_permlane16_swap_b32 v208, v210
    v_permlane16_swap_b32 v209, v211
    buffer_store_dwordx4 v[208:211], v7, s[40:43], 0 offen sc1
    v_rcp_f32 v236, v236
    s_nop 0
    v_mul_f32 v188, v188, v236
    v_mul_f32 v189, v189, v236
    v_mul_f32 v190, v190, v236
    v_mul_f32 v191, v191, v236
    v_cvt_pk_bf16_f32 v212, v188, v189
    v_cvt_pk_bf16_f32 v213, v190, v191
    v_rcp_f32 v240, v240
    s_nop 0
    v_mul_f32 v192, v192, v240
    v_mul_f32 v193, v193, v240
    v_mul_f32 v194, v194, v240
    v_mul_f32 v195, v195, v240
    v_cvt_pk_bf16_f32 v214, v192, v193
    v_cvt_pk_bf16_f32 v215, v194, v195
    s_nop 0
    v_permlane16_swap_b32 v212, v214
    v_permlane16_swap_b32 v213, v215
    buffer_store_dwordx4 v[212:215], v7, s[40:43], s71 offen sc1
    s_cmp_eq_u32 s54, 0
    s_cbranch_scc1 L_slow_17
L_join_18:
    s_mov_b32 s67, 0x1fc00
    buffer_load_dwordx4 v20, s[24:27], s67 offen offset:1024 lds
    v_lshrrev_b32 v16, 4, v1
    v_mul_u32_u24 v10, 1024, v16
    v_bfe_u32 v16, v1, 2, 2
    v_lshl_add_u32 v10, v16, 7, v10
    s_mov_b32 s67, 0x21800
    buffer_load_dwordx4 v20, s[24:27], s67 offen offset:2048 lds
    v_bfe_u32 v16, v1, 3, 2
    v_xor_b32 v16, 0, v16
    v_lshl_add_u32 v10, v16, 5, v10
    v_and_b32 v16, 3, v1
    s_add_u32 m0, s68, 65536
    s_mov_b32 s67, 0x0
    buffer_load_dwordx4 v252, s[20:23], s67 offen offset:0 lds
    v_lshl_add_u32 v10, v16, 3, v10
    v_xor_b32 v11, 32, v10
    v_xor_b32 v12, 64, v10
    buffer_load_dwordx4 v253, s[20:23], s67 offen offset:1024 lds
    v_xor_b32 v13, 96, v10
    s_mov_b32 s66, 0x4e20
    s_waitcnt vmcnt(6)
L_chk_19:
    v_cmp_ne_u64 vcc, s[44:45], v[82:83]
    v_cmp_ne_u64 s[6:7], s[44:45], v[86:87]
    s_or_b64 vcc, vcc, s[6:7]
    s_cbranch_scc0 L_ok_20
    s_sub_u32 s66, s66, 1
    s_cbranch_scc1 L_ok_20
    buffer_load_dwordx4 v[80:83], v248, s[40:43], 0 offen sc1
    buffer_load_dwordx4 v[84:87], v248, s[40:43], s4 offen sc1
    s_waitcnt vmcnt(0)
    s_branch L_chk_19
L_ok_20:
    ds_write_b64 v249, v[80:81]
    ds_write_b64 v249, v[84:85] offset:2048
    buffer_load_dwordx4 v254, s[20:23], s67 offen offset:2048 lds
    ds_read_b64_tr_b16 a[0:1], v21 offset:12288
    ds_read_b64_tr_b16 a[4:5], v22 offset:12288
    ds_read_b64_tr_b16 a[2:3], v21 offset:13312
    ds_read_b64_tr_b16 a[6:7], v22 offset:13312
    ds_read_b64_tr_b16 a[8:9], v21 offset:14336
    ds_read_b64_tr_b16 a[12:13], v22 offset:14336
    s_waitcnt lgkmcnt(0)
    s_add_u32 m0, s68, 90112
    s_mov_b32 s67, 0x56000
    buffer_load_dwordx4 v252, s[20:23], s67 offen offset:0 lds
    s_waitcnt vmcnt(6)
    buffer_store_dwordx2 v[8:9], v6, s[40:43], 0 offen offset:0
    s_barrier
    buffer_load_dwordx4 v253, s[20:23], s67 offen offset:1024 lds
    buffer_store_dwordx4 v[244:247], v250, s[36:39], s74 offen offset:0 sc1
    buffer_store_dwordx4 v[244:247], v250, s[36:39], s74 offen offset:2048 sc1
    buffer_store_dword v244, v251, s[40:43], s75 offen
    s_lshl_b32 s55, s50, 7
    s_add_u32 s55, s55, 159744
    v_lshrrev_b32 v14, 4, v1
    v_lshl_add_u32 v14, v14, 3, s55
    ds_read_b64 v[42:43], v14 offset:0
    ds_read_b64 v[58:59], v14 offset:2048
    ds_read_b64 v[46:47], v14 offset:32
    ds_read_b64 v[62:63], v14 offset:2080
    ds_read_b64 v[50:51], v14 offset:64
    ds_read_b64 v[66:67], v14 offset:2112
    ds_read_b64 v[54:55], v14 offset:96
    ds_read_b64 v[70:71], v14 offset:2144
    s_and_b32 s56, s46, 1
    s_lshl_b32 s56, s56, 6
    s_add_u32 s55, s55, s56
    v_lshrrev_b32 v15, 5, v1
    v_lshl_add_u32 v14, v15, 3, s55
    ds_read_b64 a[248:249], v14 offset:3072
    ds_read_b64 a[250:251], v14 offset:3088
    ds_read_b64 a[252:253], v14 offset:3104
    ds_read_b64 a[254:255], v14 offset:3120
    s_lshl_b32 s55, s46, 8
    s_add_u32 s55, s55, 160768
    v_lshl_add_u32 v15, v15, 3, s55
    v_and_b32 v14, 4, v1
    v_lshl_add_u32 v14, v14, 8, v15
    ds_read_b64 a[192:193], v14 offset:0
    ds_read_b64 a[194:195], v14 offset:32
    buffer_load_dwordx4 v254, s[20:23], s67 offen offset:2048 lds
    ds_read_b64_tr_b16 a[10:11], v21 offset:24576
    ds_read_b64_tr_b16 a[14:15], v22 offset:24576
    ds_read_b64_tr_b16 a[16:17], v21 offset:25600
    ds_read_b64_tr_b16 a[20:21], v22 offset:25600
    ds_read_b64_tr_b16 a[18:19], v21 offset:26624
    s_mov_b64 exec, s[82:83]
    buffer_load_dwordx2 v[4:5], v3, s[40:43], 0 offen offset:0 sc1
    s_mov_b64 exec, -1
    ds_read_b64_tr_b16 a[22:23], v22 offset:26624
    ds_read_b64 a[196:197], v14 offset:16
    ds_read_b64 a[198:199], v14 offset:48
    ds_read_b64 a[200:201], v14 offset:64
    ds_read_b64 a[202:203], v14 offset:96
    ds_read_b64 a[204:205], v14 offset:80
    ds_read_b64 a[206:207], v14 offset:112
    ds_read_b64 a[208:209], v14 offset:128
    ds_read_b64 a[210:211], v14 offset:160
    ds_read_b64 a[212:213], v14 offset:144
    ds_read_b64 a[214:215], v14 offset:176
    ds_read_b64 a[216:217], v14 offset:192
    ds_read_b64 a[218:219], v14 offset:224
    ds_read_b64 a[220:221], v14 offset:208
    ds_read_b64 a[222:223], v14 offset:240
    ds_read_b64_tr_b16 a[80:81], v10 offset:0
    ds_read_b64_tr_b16 a[82:83], v10 offset:512
    ds_read_b64_tr_b16 a[84:85], v11 offset:0
    ds_read_b64_tr_b16 a[86:87], v11 offset:512
    ds_read_b64_tr_b16 a[88:89], v12 offset:0
    ds_read_b64_tr_b16 a[90:91], v12 offset:512
    ds_read_b64_tr_b16 a[92:93], v13 offset:0
    s_waitcnt lgkmcnt(15)
    s_add_u32 m0, s68, 102400
    s_mov_b32 s67, 0x81000
    buffer_load_dwordx4 v252, s[20:23], s67 offen offset:0 lds
    ds_read_b64_tr_b16 a[94:95], v13 offset:512
    ds_read_b64_tr_b16 a[96:97], v10 offset:4096
    ds_read_b64_tr_b16 a[98:99], v10 offset:4608
    ds_read_b64_tr_b16 a[100:101], v11 offset:4096
    ds_read_b64_tr_b16 a[102:103], v11 offset:4608
    ds_read_b64_tr_b16 a[104:105], v12 offset:4096
    ds_read_b64_tr_b16 a[106:107], v12 offset:4608
    ds_read_b64_tr_b16 a[108:109], v13 offset:4096
    ds_read_b64_tr_b16 a[110:111], v13 offset:4608
    ds_read_b64_tr_b16 a[112:113], v10 offset:8192
    ds_read_b64_tr_b16 a[114:115], v10 offset:8704
    ds_read_b64_tr_b16 a[116:117], v11 offset:8192
    ds_read_b64_tr_b16 a[118:119], v11 offset:8704
    ds_read_b64_tr_b16 a[120:121], v12 offset:8192
    ds_read_b64_tr_b16 a[122:123], v12 offset:8704
    ds_read_b64_tr_b16 a[124:125], v13 offset:8192
    ds_read_b64_tr_b16 a[126:127], v13 offset:8704
    ds_read_b64_tr_b16 a[128:129], v10 offset:12288
    ds_read_b64_tr_b16 a[130:131], v10 offset:12800
    ds_read_b64_tr_b16 a[132:133], v11 offset:12288
    ds_read_b64_tr_b16 a[134:135], v11 offset:12800
    ds_read_b64_tr_b16 a[136:137], v12 offset:12288
    ds_read_b64_tr_b16 a[138:139], v12 offset:12800
    ds_read_b64_tr_b16 a[140:141], v13 offset:12288
    ds_read_b64_tr_b16 a[142:143], v13 offset:12800
    buffer_load_dwordx4 v253, s[20:23], s67 offen offset:1024 lds
    ds_read_b64_tr_b16 a[144:145], v10 offset:16384
    ds_read_b64_tr_b16 a[146:147], v10 offset:16896
    ds_read_b64_tr_b16 a[148:149], v11 offset:16384
    ds_read_b64_tr_b16 a[150:151], v11 offset:16896
    ds_read_b64_tr_b16 a[152:153], v12 offset:16384
    ds_read_b64_tr_b16 a[154:155], v12 offset:16896
    ds_read_b64_tr_b16 a[156:157], v13 offset:16384
    ds_read_b64_tr_b16 a[158:159], v13 offset:16896
    v_bfe_u32 v24, v1, 4, 1
    v_and_b32 v25, 0xf0, v2
    v_lshl_add_u32 v25, v24, 3, v25
    v_lshrrev_b32 v24, 5, v1
    v_lshl_add_u32 v25, v24, 2, v25
    ds_bpermute_b32 v88, v25, v88
    ds_bpermute_b32 v89, v25, v89
    ds_bpermute_b32 v90, v25, v90
    ds_bpermute_b32 v91, v25, v91
    ds_bpermute_b32 v92, v25, v92
    ds_bpermute_b32 v93, v25, v93
    ds_bpermute_b32 v94, v25, v94
    ds_bpermute_b32 v95, v25, v95
    v_lshlrev_b32 v40, 16, v42
    v_and_b32 v41, 0xffff0000, v42
    v_lshlrev_b32 v42, 16, v43
    v_and_b32 v43, 0xffff0000, v43
    v_lshlrev_b32 v44, 16, v46
    v_and_b32 v45, 0xffff0000, v46
    v_lshlrev_b32 v46, 16, v47
    buffer_load_dwordx4 v254, s[20:23], s67 offen offset:2048 lds
    ds_read_b64_tr_b16 a[24:25], v21 offset:36864
    ds_read_b64_tr_b16 a[28:29], v22 offset:36864
    ds_read_b64_tr_b16 a[26:27], v21 offset:37888
    ds_read_b64_tr_b16 a[30:31], v22 offset:37888
    ds_read_b64_tr_b16 a[32:33], v21 offset:38912
    ds_read_b64_tr_b16 a[36:37], v22 offset:38912
    v_and_b32 v47, 0xffff0000, v47
    v_lshlrev_b32 v48, 16, v50
    v_and_b32 v49, 0xffff0000, v50
    v_lshlrev_b32 v50, 16, v51
    v_and_b32 v51, 0xffff0000, v51
    v_lshlrev_b32 v52, 16, v54
    v_and_b32 v53, 0xffff0000, v54
    v_lshlrev_b32 v54, 16, v55
    v_and_b32 v55, 0xffff0000, v55
    v_lshlrev_b32 v56, 16, v58
    v_and_b32 v57, 0xffff0000, v58
    v_lshlrev_b32 v58, 16, v59
    v_and_b32 v59, 0xffff0000, v59
    v_lshlrev_b32 v60, 16, v62
    v_and_b32 v61, 0xffff0000, v62
    v_lshlrev_b32 v62, 16, v63
    v_and_b32 v63, 0xffff0000, v63
    v_lshlrev_b32 v64, 16, v66
    v_and_b32 v65, 0xffff0000, v66
    v_lshlrev_b32 v66, 16, v67
    v_and_b32 v67, 0xffff0000, v67
    s_waitcnt lgkmcnt(0)
    s_mov_b32 s66, 0x4e20
    s_waitcnt vmcnt(3)
L_chk_21:
    v_cmp_ne_u64 vcc, s[44:45], v[4:5]
    s_and_b64 vcc, vcc, s[82:83]
    s_cbranch_scc0 L_ok_22
    s_sub_u32 s66, s66, 1
    s_cbranch_scc1 L_ok_22
    s_mov_b64 exec, s[82:83]
    buffer_load_dwordx2 v[4:5], v3, s[40:43], 0 offen offset:0 sc1
    s_mov_b64 exec, -1
    s_waitcnt vmcnt(0)
    s_branch L_chk_21
L_ok_22:
    buffer_load_dwordx4 v[96:99], v2, s[40:43], s72 offen offset:0 sc1
    s_add_u32 m0, s68, 114688
    buffer_load_dwordx4 v[100:103], v2, s[40:43], s72 offen offset:1024 sc1
    s_mov_b32 s67, 0xac000
    buffer_load_dwordx4 v[104:107], v2, s[40:43], s72 offen offset:2048 sc1
    buffer_load_dwordx4 v252, s[20:23], s67 offen offset:0 lds
    buffer_load_dwordx4 v[108:111], v2, s[40:43], s72 offen offset:3072 sc1
    v_lshlrev_b32 v68, 16, v70
    s_add_u32 s72, s72, 4096
    buffer_load_dwordx4 v[112:115], v2, s[40:43], s72 offen offset:0 sc1
    v_and_b32 v69, 0xffff0000, v70
    buffer_load_dwordx4 v[116:119], v2, s[40:43], s72 offen offset:1024 sc1
    v_lshlrev_b32 v70, 16, v71
    buffer_load_dwordx4 v[120:123], v2, s[40:43], s72 offen offset:2048 sc1
    v_and_b32 v71, 0xffff0000, v71
    buffer_load_dwordx4 v[124:127], v2, s[40:43], s72 offen offset:3072 sc1
    v_permlane16_swap_b32 v88, v90
    s_add_u32 s72, s72, 4096
    buffer_load_dwordx4 v[128:131], v2, s[40:43], s72 offen offset:0 sc1
    v_permlane16_swap_b32 v89, v91
    buffer_load_dwordx4 v[132:135], v2, s[40:43], s72 offen offset:1024 sc1
    v_permlane16_swap_b32 v92, v94
    buffer_load_dwordx4 v[136:139], v2, s[40:43], s72 offen offset:2048 sc1
    v_permlane16_swap_b32 v93, v95
    buffer_load_dwordx4 v[140:143], v2, s[40:43], s72 offen offset:3072 sc1
    v_lshlrev_b32 v24, 16, v88
    s_add_u32 s72, s72, 4096
    buffer_load_dwordx4 v[144:147], v2, s[40:43], s72 offen offset:0 sc1
    v_and_b32 v25, 0xffff0000, v88
    buffer_load_dwordx4 v[148:151], v2, s[40:43], s72 offen offset:1024 sc1
    v_lshlrev_b32 v26, 16, v89
    v_and_b32 v27, 0xffff0000, v89
    v_lshlrev_b32 v28, 16, v90
    v_and_b32 v29, 0xffff0000, v90
    v_lshlrev_b32 v30, 16, v91
    v_and_b32 v31, 0xffff0000, v91
    v_lshlrev_b32 v32, 16, v92
    v_and_b32 v33, 0xffff0000, v92
    v_lshlrev_b32 v34, 16, v93
    v_and_b32 v35, 0xffff0000, v93
    v_lshlrev_b32 v36, 16, v94
    v_and_b32 v37, 0xffff0000, v94
    v_lshlrev_b32 v38, 16, v95
    v_and_b32 v39, 0xffff0000, v95
    ds_read_b64_tr_b16 a[160:161], v10 offset:20480
    ds_read_b64_tr_b16 a[162:163], v10 offset:20992
    ds_read_b64_tr_b16 a[164:165], v11 offset:20480
    ds_read_b64_tr_b16 a[166:167], v11 offset:20992
    ds_read_b64_tr_b16 a[168:169], v12 offset:20480
    ds_read_b64_tr_b16 a[170:171], v12 offset:20992
    ds_read_b64_tr_b16 a[172:173], v13 offset:20480
    ds_read_b64_tr_b16 a[174:175], v13 offset:20992
    ds_read_b64_tr_b16 a[176:177], v10 offset:24576
    ds_read_b64_tr_b16 a[178:179], v10 offset:25088
    ds_read_b64_tr_b16 a[180:181], v11 offset:24576
    ds_read_b64_tr_b16 a[182:183], v11 offset:25088
    ds_read_b64_tr_b16 a[184:185], v12 offset:24576
    ds_read_b64_tr_b16 a[186:187], v12 offset:25088
    ds_read_b64_tr_b16 a[188:189], v13 offset:24576
    ds_read_b64_tr_b16 a[190:191], v13 offset:25088
    ds_read_b64_tr_b16 v[160:161], v10 offset:28672
    ds_read_b64_tr_b16 v[162:163], v10 offset:29184
    ds_read_b64_tr_b16 v[164:165], v11 offset:28672
    ds_read_b64_tr_b16 v[166:167], v11 offset:29184
    ds_read_b64_tr_b16 v[168:169], v12 offset:28672
    ds_read_b64_tr_b16 v[170:171], v12 offset:29184
    ds_read_b64_tr_b16 v[172:173], v13 offset:28672
    ds_read_b64_tr_b16 v[174:175], v13 offset:29184
    s_waitcnt vmcnt(14)
    v_mfma_f32_16x16x32_bf16 v[72:75], a[80:83], v[96:99], 0
    buffer_load_dwordx4 v[152:155], v2, s[40:43], s72 offen offset:2048 sc1
    v_mfma_f32_16x16x32_bf16 v[76:79], a[84:87], v[96:99], 0
    ds_read_b64_tr_b16 v[176:177], v10 offset:32768
    ds_read_b64_tr_b16 v[178:179], v10 offset:33280
    ds_read_b64_tr_b16 v[180:181], v11 offset:32768
    v_mfma_f32_16x16x32_bf16 v[80:83], a[88:91], v[96:99], 0
    ds_read_b64_tr_b16 v[182:183], v11 offset:33280
    ds_read_b64_tr_b16 v[184:185], v12 offset:32768
    ds_read_b64_tr_b16 v[186:187], v12 offset:33280
    v_mfma_f32_16x16x32_bf16 v[84:87], a[92:95], v[96:99], 0
    ds_read_b64_tr_b16 v[188:189], v13 offset:32768
    s_waitcnt vmcnt(14)
    v_mfma_f32_16x16x32_bf16 v[72:75], a[96:99], v[100:103], v[72:75]
    buffer_load_dwordx4 v[156:159], v2, s[40:43], s72 offen offset:3072 sc1
    ds_read_b64_tr_b16 v[190:191], v13 offset:33280
    v_mfma_f32_16x16x32_bf16 v[76:79], a[100:103], v[100:103], v[76:79]
    ds_read_b64_tr_b16 v[192:193], v10 offset:36864
    ds_read_b64_tr_b16 v[194:195], v10 offset:37376
    v_mfma_f32_16x16x32_bf16 v[80:83], a[104:107], v[100:103], v[80:83]
    ds_read_b64_tr_b16 v[196:197], v11 offset:36864
    ds_read_b64_tr_b16 v[198:199], v11 offset:37376
    v_mfma_f32_16x16x32_bf16 v[84:87], a[108:111], v[100:103], v[84:87]
    ds_read_b64_tr_b16 v[200:201], v12 offset:36864
    s_waitcnt vmcnt(14)
    v_mfma_f32_16x16x32_bf16 v[72:75], a[112:115], v[104:107], v[72:75]
    buffer_store_dwordx2 v[8:9], v6, s[40:43], 0 offen offset:512
    buffer_load_dwordx4 v253, s[20:23], s67 offen offset:1024 lds
    v_mfma_f32_16x16x32_bf16 v[76:79], a[116:119], v[104:107], v[76:79]
    ds_read_b64_tr_b16 v[202:203], v12 offset:37376
    ds_read_b64_tr_b16 v[204:205], v13 offset:36864
    ds_read_b64_tr_b16 v[206:207], v13 offset:37376
    v_mfma_f32_16x16x32_bf16 v[80:83], a[120:123], v[104:107], v[80:83]
    ds_read_b64_tr_b16 v[208:209], v10 offset:40960
    ds_read_b64_tr_b16 v[210:211], v10 offset:41472
    v_mfma_f32_16x16x32_bf16 v[84:87], a[124:127], v[104:107], v[84:87]
    ds_read_b64_tr_b16 v[212:213], v11 offset:40960
    ds_read_b64_tr_b16 v[214:215], v11 offset:41472
    s_waitcnt vmcnt(14)
    v_mfma_f32_16x16x32_bf16 v[72:75], a[128:131], v[108:111], v[72:75]
    buffer_load_dwordx4 v254, s[20:23], s67 offen offset:2048 lds
    ds_read_b64_tr_b16 a[34:35], v21 offset:49152
    ds_read_b64_tr_b16 a[38:39], v22 offset:49152
    ds_read_b64_tr_b16 a[40:41], v21 offset:50176
    ds_read_b64_tr_b16 a[44:45], v22 offset:50176
    ds_read_b64_tr_b16 a[42:43], v21 offset:51200
    ds_read_b64_tr_b16 a[46:47], v22 offset:51200
    v_mfma_f32_16x16x32_bf16 v[76:79], a[132:135], v[108:111], v[76:79]
    v_mfma_f32_16x16x32_bf16 v[80:83], a[136:139], v[108:111], v[80:83]
    ds_read_b64_tr_b16 v[216:217], v12 offset:40960
    ds_read_b64_tr_b16 v[218:219], v12 offset:41472
    ds_read_b64_tr_b16 v[220:221], v13 offset:40960
    v_mfma_f32_16x16x32_bf16 v[84:87], a[140:143], v[108:111], v[84:87]
    ds_read_b64_tr_b16 v[222:223], v13 offset:41472
    ds_read_b64_tr_b16 v[224:225], v10 offset:45056
    ds_read_b64_tr_b16 v[226:227], v10 offset:45568
    s_waitcnt vmcnt(14)
    v_mfma_f32_16x16x32_bf16 v[72:75], a[144:147], v[112:115], v[72:75]
    s_waitcnt lgkmcnt(6)
    s_add_u32 m0, s68, 126976
    s_mov_b32 s67, 0xd7000
    buffer_load_dwordx4 v252, s[20:23], s67 offen offset:0 lds
    v_mfma_f32_16x16x32_bf16 v[76:79], a[148:151], v[112:115], v[76:79]
    v_mfma_f32_16x16x32_bf16 v[80:83], a[152:155], v[112:115], v[80:83]
    ds_read_b64_tr_b16 v[228:229], v11 offset:45056
    ds_read_b64_tr_b16 v[230:231], v11 offset:45568
    ds_read_b64_tr_b16 v[232:233], v12 offset:45056
    v_mfma_f32_16x16x32_bf16 v[84:87], a[156:159], v[112:115], v[84:87]
    ds_read_b64_tr_b16 v[234:235], v12 offset:45568
    ds_read_b64_tr_b16 v[236:237], v13 offset:45056
    ds_read_b64_tr_b16 v[238:239], v13 offset:45568
    s_waitcnt vmcnt(14)
    v_mfma_f32_16x16x32_bf16 v[72:75], a[160:163], v[116:119], v[72:75]
    buffer_load_dwordx4 v253, s[20:23], s67 offen offset:1024 lds
    v_mfma_f32_16x16x32_bf16 v[76:79], a[164:167], v[116:119], v[76:79]
    ds_read_b64_tr_b16 a[80:81], v10 offset:49152
    ds_read_b64_tr_b16 a[82:83], v10 offset:49664
    ds_read_b64_tr_b16 a[84:85], v11 offset:49152
    v_mfma_f32_16x16x32_bf16 v[80:83], a[168:171], v[116:119], v[80:83]
    ds_read_b64_tr_b16 a[86:87], v11 offset:49664
    v_mfma_f32_16x16x32_bf16 v[84:87], a[172:175], v[116:119], v[84:87]
    ds_read_b64_tr_b16 a[88:89], v12 offset:49152
    ds_read_b64_tr_b16 a[90:91], v12 offset:49664
    s_waitcnt vmcnt(14)
    v_mfma_f32_16x16x32_bf16 v[72:75], a[176:179], v[120:123], v[72:75]
    buffer_load_dwordx4 v254, s[20:23], s67 offen offset:2048 lds
    ds_read_b64_tr_b16 a[48:49], v21 offset:61440
    ds_read_b64_tr_b16 a[52:53], v22 offset:61440
    ds_read_b64_tr_b16 a[50:51], v21 offset:62464
    ds_read_b64_tr_b16 a[54:55], v22 offset:62464
    ds_read_b64_tr_b16 a[56:57], v21 offset:63488
    ds_read_b64_tr_b16 a[60:61], v22 offset:63488
    v_mfma_f32_16x16x32_bf16 v[76:79], a[180:183], v[120:123], v[76:79]
    v_mfma_f32_16x16x32_bf16 v[80:83], a[184:187], v[120:123], v[80:83]
    ds_read_b64_tr_b16 a[92:93], v13 offset:49152
    ds_read_b64_tr_b16 a[94:95], v13 offset:49664
    ds_read_b64_tr_b16 a[96:97], v10 offset:53248
    v_mfma_f32_16x16x32_bf16 v[84:87], a[188:191], v[120:123], v[84:87]
    ds_read_b64_tr_b16 a[98:99], v10 offset:53760
    ds_read_b64_tr_b16 a[100:101], v11 offset:53248
    s_waitcnt vmcnt(14)
    v_mfma_f32_16x16x32_bf16 v[72:75], v[160:163], v[124:127], v[72:75]
    s_waitcnt lgkmcnt(5)
    s_add_u32 m0, s68, 139264
    s_mov_b32 s67, 0x102000
    buffer_load_dwordx4 v252, s[20:23], s67 offen offset:0 lds
    v_mfma_f32_16x16x32_bf16 v[76:79], v[164:167], v[124:127], v[76:79]
    ds_read_b64_tr_b16 a[102:103], v11 offset:53760
    v_mfma_f32_16x16x32_bf16 v[80:83], v[168:171], v[124:127], v[80:83]
    ds_read_b64_tr_b16 a[104:105], v12 offset:53248
    ds_read_b64_tr_b16 a[106:107], v12 offset:53760
    v_mfma_f32_16x16x32_bf16 v[84:87], v[172:175], v[124:127], v[84:87]
    ds_read_b64_tr_b16 a[108:109], v13 offset:53248
    ds_read_b64_tr_b16 a[110:111], v13 offset:53760
    ds_read_b64_tr_b16 a[112:113], v10 offset:57344
    s_waitcnt vmcnt(14)
    v_mfma_f32_16x16x32_bf16 v[72:75], v[176:179], v[128:131], v[72:75]
    buffer_load_dwordx4 v253, s[20:23], s67 offen offset:1024 lds
    ds_read_b64_tr_b16 a[114:115], v10 offset:57856
    v_mfma_f32_16x16x32_bf16 v[76:79], v[180:183], v[128:131], v[76:79]
    ds_read_b64_tr_b16 a[116:117], v11 offset:57344
    ds_read_b64_tr_b16 a[118:119], v11 offset:57856
    v_mfma_f32_16x16x32_bf16 v[80:83], v[184:187], v[128:131], v[80:83]
    ds_read_b64_tr_b16 a[120:121], v12 offset:57344
    ds_read_b64_tr_b16 a[122:123], v12 offset:57856
    ds_read_b64_tr_b16 a[124:125], v13 offset:57344
    v_mfma_f32_16x16x32_bf16 v[84:87], v[188:191], v[128:131], v[84:87]
    ds_read_b64_tr_b16 a[126:127], v13 offset:57856
    v_lshrrev_b32 v16, 5, v1
    s_waitcnt vmcnt(14)
    v_mfma_f32_16x16x32_bf16 v[72:75], v[192:195], v[132:135], v[72:75]
    buffer_load_dwordx4 v254, s[20:23], s67 offen offset:2048 lds
    ds_read_b64_tr_b16 a[58:59], v21 offset:0
    ds_read_b64_tr_b16 a[62:63], v22 offset:0
    ds_read_b64_tr_b16 a[64:65], v21 offset:1024
    ds_read_b64_tr_b16 a[68:69], v22 offset:1024
    ds_read_b64_tr_b16 a[66:67], v21 offset:2048
    ds_read_b64_tr_b16 a[70:71], v22 offset:2048
    v_mfma_f32_16x16x32_bf16 v[76:79], v[196:199], v[132:135], v[76:79]
    v_mfma_f32_16x16x32_bf16 v[80:83], v[200:203], v[132:135], v[80:83]
    ds_read_b64_tr_b16 a[128:129], v10 offset:61440
    v_bfe_u32 v14, v1, 2, 2
    v_mfma_f32_16x16x32_bf16 v[84:87], v[204:207], v[132:135], v[84:87]
    ds_read_b64_tr_b16 a[130:131], v10 offset:61952
    v_lshl_add_u32 v16, v16, 2, v14
    v_mul_u32_u24 v14, 192, v16
    s_waitcnt vmcnt(14)
    v_mfma_f32_16x16x32_bf16 v[72:75], v[208:211], v[136:139], v[72:75]
    s_waitcnt lgkmcnt(2)
    s_add_u32 m0, s68, 77824
    s_mov_b32 s67, 0x2b000
    buffer_load_dwordx4 v252, s[20:23], s67 offen offset:0 lds
    v_mfma_f32_16x16x32_bf16 v[76:79], v[212:215], v[136:139], v[76:79]
    ds_read_b64_tr_b16 a[132:133], v11 offset:61440
    ds_read_b64_tr_b16 a[134:135], v11 offset:61952
    v_mfma_f32_16x16x32_bf16 v[80:83], v[216:219], v[136:139], v[80:83]
    ds_read_b64_tr_b16 a[136:137], v12 offset:61440
    ds_read_b64_tr_b16 a[138:139], v12 offset:61952
    v_bfe_u32 v16, v1, 4, 1
    v_lshl_add_u32 v14, v16, 5, v14
    v_mfma_f32_16x16x32_bf16 v[84:87], v[220:223], v[136:139], v[84:87]
    ds_read_b64_tr_b16 a[140:141], v13 offset:61440
    v_and_b32 v16, 3, v1
    s_waitcnt vmcnt(14)
    v_mfma_f32_16x16x32_bf16 v[72:75], v[224:227], v[140:143], v[72:75]
    buffer_load_dwordx4 v253, s[20:23], s67 offen offset:1024 lds
    ds_read_b64_tr_b16 a[142:143], v13 offset:61952
    v_lshl_add_u32 v14, v16, 3, v14
    v_add_u32 v14, 65536, v14
    v_mfma_f32_16x16x32_bf16 v[76:79], v[228:231], v[140:143], v[76:79]
    v_add_u32 v15, 49152, v14
    v_mfma_f32_16x16x32_bf16 v[80:83], v[232:235], v[140:143], v[80:83]
    s_mul_i32 s55, s46, 24576
    v_mfma_f32_16x16x32_bf16 v[84:87], v[236:239], v[140:143], v[84:87]
    v_add_u32 v23, s55, v14
    v_and_b32 v17, 0x200, v2
    v_add_u32 v16, v2, v17
    s_waitcnt vmcnt(14)
    v_mfma_f32_16x16x32_bf16 v[72:75], a[80:83], v[144:147], v[72:75]
    buffer_load_dwordx4 v254, s[20:23], s67 offen offset:2048 lds
    v_mfma_f32_16x16x32_bf16 v[76:79], a[84:87], v[144:147], v[76:79]
    s_lshl_b32 s55, s51, 2
    s_add_u32 s55, s55, s46
    v_mfma_f32_16x16x32_bf16 v[80:83], a[88:91], v[144:147], v[80:83]
    s_lshl_b32 s73, s55, 11
    s_add_u32 s73, s73, 131072
    s_lshl_b32 s35, s55, 15
    v_mfma_f32_16x16x32_bf16 v[84:87], a[92:95], v[144:147], v[84:87]
    s_mul_i32 s55, s55, 88064
    s_mul_i32 s56, s77, 6144
    s_waitcnt vmcnt(14)
    v_mfma_f32_16x16x32_bf16 v[72:75], a[96:99], v[148:151], v[72:75]
    s_barrier
    s_add_u32 m0, s68, 151552
    s_mov_b32 s67, 0x12d000
    buffer_load_dwordx4 v252, s[20:23], s67 offen offset:0 lds
    v_mfma_f32_16x16x32_bf16 v[76:79], a[100:103], v[148:151], v[76:79]
    s_add_u32 s55, s55, s56
    v_mfma_f32_16x16x32_bf16 v[80:83], a[104:107], v[148:151], v[80:83]
    s_add_u32 s32, s55, 6160384
    v_mfma_f32_16x16x32_bf16 v[84:87], a[108:111], v[148:151], v[84:87]
    s_add_u32 s33, s32, 2048
    s_add_u32 s34, s32, 4096
    s_waitcnt vmcnt(14)
    v_mfma_f32_16x16x32_bf16 v[72:75], a[112:115], v[152:155], v[72:75]
    buffer_load_dwordx4 v253, s[20:23], s67 offen offset:1024 lds
    s_cmp_ge_u32 s77, 14
    s_cselect_b32 s33, 0x40000000, s33
    s_cselect_b32 s34, 0x40000000, s34
    v_mfma_f32_16x16x32_bf16 v[76:79], a[116:119], v[152:155], v[76:79]
    v_mfma_f32_16x16x32_bf16 v[80:83], a[120:123], v[152:155], v[80:83]
    s_cmp_eq_u32 s77, 15
    s_cselect_b32 s32, 0x40000000, s32
    s_mov_b32 s56, 0xcccccccc
    v_mfma_f32_16x16x32_bf16 v[84:87], a[124:127], v[152:155], v[84:87]
    s_bitcmp1_b32 s46, 0
    s_cselect_b32 s55, s56, 0x33333333
    s_waitcnt vmcnt(14) lgkmcnt(6)
    v_mfma_f32_16x16x32_bf16 v[72:75], a[128:131], v[156:159], v[72:75]
    buffer_load_dwordx4 v254, s[20:23], s67 offen offset:2048 lds
    s_waitcnt lgkmcnt(4)
    v_mfma_f32_16x16x32_bf16 v[76:79], a[132:135], v[156:159], v[76:79]
    s_bitcmp1_b32 s46, 1
    s_cselect_b32 s62, 0, s55
    s_cselect_b32 s63, s55, 0
    s_waitcnt lgkmcnt(2)
    v_mfma_f32_16x16x32_bf16 v[80:83], a[136:139], v[156:159], v[80:83]
    s_mul_i32 s55, s46, 768
    s_add_u32 s55, s55, 61440
    v_lshl_add_u32 v17, v1, 2, s55
    s_waitcnt lgkmcnt(0)
    v_mfma_f32_16x16x32_bf16 v[84:87], a[140:143], v[156:159], v[84:87]
    v_lshlrev_b32 v7, 2, v1
    v_add_u32 v7, 61440, v7
    buffer_load_dwordx2 v[4:5], v3, s[40:43], s81 offen offset:512 sc1
    v_pk_fma_f32 v[24:25], v[72:73], v[40:41], v[24:25]
    v_pk_fma_f32 v[26:27], v[74:75], v[42:43], v[26:27]
    v_pk_fma_f32 v[28:29], v[76:77], v[44:45], v[28:29]
    v_pk_fma_f32 v[30:31], v[78:79], v[46:47], v[30:31]
    v_pk_mul_f32 v[96:97], v[24:25], v[56:57]
    v_pk_mul_f32 v[98:99], v[26:27], v[58:59]
    v_pk_mul_f32 v[100:101], v[28:29], v[60:61]
    v_pk_mul_f32 v[102:103], v[30:31], v[62:63]
    v_cvt_pk_bf16_f32 v112, v96, v97
    v_cvt_pk_bf16_f32 v113, v98, v99
    v_cvt_pk_bf16_f32 v114, v100, v101
    v_cvt_pk_bf16_f32 v115, v102, v103
    v_min_u32 v112, -2, v112
    buffer_store_dwordx4 v[112:115], v250, s[36:39], s74 offen offset:0
    v_pk_fma_f32 v[32:33], v[80:81], v[48:49], v[32:33]
    v_pk_fma_f32 v[34:35], v[82:83], v[50:51], v[34:35]
    v_pk_fma_f32 v[36:37], v[84:85], v[52:53], v[36:37]
    v_pk_fma_f32 v[38:39], v[86:87], v[54:55], v[38:39]
    v_pk_mul_f32 v[104:105], v[32:33], v[64:65]
    v_pk_mul_f32 v[106:107], v[34:35], v[66:67]
    v_pk_mul_f32 v[108:109], v[36:37], v[68:69]
    v_pk_mul_f32 v[110:111], v[38:39], v[70:71]
    v_cvt_pk_bf16_f32 v116, v104, v105
    v_cvt_pk_bf16_f32 v117, v106, v107
    v_cvt_pk_bf16_f32 v118, v108, v109
    v_cvt_pk_bf16_f32 v119, v110, v111
    v_min_u32 v116, -2, v116
    buffer_store_dwordx4 v[116:119], v250, s[36:39], s74 offen offset:2048
    v_pk_add_f32 v[120:121], v[24:25], v[26:27]
    v_pk_mul_f32 v[122:123], v[24:25], v[24:25]
    v_pk_fma_f32 v[122:123], v[26:27], v[26:27], v[122:123]
    v_pk_add_f32 v[120:121], v[120:121], v[28:29]
    v_pk_fma_f32 v[122:123], v[28:29], v[28:29], v[122:123]
    v_pk_add_f32 v[120:121], v[120:121], v[30:31]
    v_pk_fma_f32 v[122:123], v[30:31], v[30:31], v[122:123]
    v_pk_add_f32 v[120:121], v[120:121], v[32:33]
    v_pk_fma_f32 v[122:123], v[32:33], v[32:33], v[122:123]
    v_pk_add_f32 v[120:121], v[120:121], v[34:35]
    v_pk_fma_f32 v[122:123], v[34:35], v[34:35], v[122:123]
    v_pk_add_f32 v[120:121], v[120:121], v[36:37]
    v_pk_fma_f32 v[122:123], v[36:37], v[36:37], v[122:123]
    v_pk_add_f32 v[120:121], v[120:121], v[38:39]
    v_pk_fma_f32 v[122:123], v[38:39], v[38:39], v[122:123]
    v_add_f32 v120, v120, v121
    v_add_f32 v122, v122, v123
    s_nop 1
    v_permlane16_swap_b32 v120, v122
    v_add_f32 v120, v120, v122
    v_mov_b32 v122, v120
    s_nop 1
    v_permlane32_swap_b32 v120, v122
    v_add_f32 v120, v120, v122
    v_min_u32 v120, -2, v120
    buffer_store_dword v120, v251, s[40:43], s75 offen
    s_cmp_eq_u32 s54, 0
    s_cbranch_scc1 L_slow_23
L_join_24:
    s_mul_i32 s76, s46, 352
    s_add_u32 s76, s76, 272
    v_lshl_add_u32 v18, v1, 2, s76
    s_lshr_b32 s76, s48, 3
    v_add_u32 v18, s76, v18
    s_lshl_b32 s76, s50, 7
    v_lshl_add_u32 v18, v18, 10, s76
    s_bfm_b64 exec, 20, 0
    buffer_load_dword a247, v18, s[24:27], 0 offen
    s_mov_b64 exec, -1
    s_mov_b32 s66, 0x4e20
    s_waitcnt vmcnt(4)
L_chk_25:
    v_cmp_ne_u64 vcc, s[44:45], v[4:5]
    s_and_b64 vcc, vcc, s[62:63]
    s_cbranch_scc0 L_ok_26
    s_sub_u32 s66, s66, 1
    s_cbranch_scc1 L_ok_26
    buffer_load_dwordx2 v[4:5], v3, s[40:43], s81 offen offset:512 sc1
    s_waitcnt vmcnt(0)
    s_branch L_chk_25
L_ok_26:
    s_barrier
    ds_read_b64_tr_b16 v[88:89], v23 offset:0
    ds_read_b64_tr_b16 v[90:91], v23 offset:3072
    ds_read_b64_tr_b16 v[92:93], v23 offset:64
    ds_read_b64_tr_b16 v[94:95], v23 offset:3136
    ds_read_b64_tr_b16 v[96:97], v23 offset:128
    ds_read_b64_tr_b16 v[98:99], v23 offset:3200
    ds_read_b64_tr_b16 v[100:101], v23 offset:1536
    ds_read_b64_tr_b16 v[102:103], v23 offset:4608
    ds_read_b64_tr_b16 v[104:105], v23 offset:1600
    ds_read_b64_tr_b16 v[106:107], v23 offset:4672
    ds_read_b64_tr_b16 v[108:109], v23 offset:1664
    ds_read_b64_tr_b16 v[110:111], v23 offset:4736
    ds_read_b64_tr_b16 a[176:177], v23 offset:6144
    ds_read_b64_tr_b16 a[178:179], v23 offset:9216
    ds_read_b64_tr_b16 a[180:181], v23 offset:6208
    ds_read_b64_tr_b16 a[182:183], v23 offset:9280
    s_mul_i32 s55, s46, 12288
    s_sub_u32 s55, s55, 77824
    v_add_u32 v21, s55, v21
    v_add_u32 v22, s55, v22
    s_waitcnt lgkmcnt(14)
    v_mfma_f32_32x32x16_bf16 v[208:223], a[192:195], v[88:91], 0
    s_add_u32 m0, s70, 0
    s_mov_b32 s67, 0x24000
    buffer_load_dwordx4 v20, s[24:27], s67 offen lds
    ds_read_b64_tr_b16 a[184:185], v23 offset:6272
    ds_read_b64_tr_b16 a[186:187], v23 offset:9344
    s_waitcnt lgkmcnt(14)
    v_mfma_f32_32x32x16_bf16 v[224:239], a[192:195], v[92:95], 0
    ds_read_b64_tr_b16 a[188:189], v23 offset:7680
    ds_read_b64_tr_b16 a[190:191], v23 offset:10752
    ds_read_b64_tr_b16 a[224:225], v23 offset:7744
    ds_read_b64_tr_b16 a[226:227], v23 offset:10816
    s_waitcnt lgkmcnt(15)
    v_mfma_f32_32x32x16_bf16 v[240:255], a[192:195], v[96:99], 0
    ds_read_b64_tr_b16 a[228:229], v23 offset:7808
    ds_read_b64_tr_b16 a[230:231], v23 offset:10880
    s_waitcnt lgkmcnt(15)
    v_mfma_f32_32x32x16_bf16 v[208:223], a[196:199], v[100:103], v[208:223]
    ds_read_b64_tr_b16 a[232:233], v23 offset:12288
    ds_read_b64_tr_b16 a[234:235], v23 offset:15360
    s_waitcnt lgkmcnt(15)
    v_mfma_f32_32x32x16_bf16 v[224:239], a[196:199], v[104:107], v[224:239]
    ds_read_b64_tr_b16 a[236:237], v23 offset:12352
    ds_read_b64_tr_b16 a[238:239], v23 offset:15424
    s_waitcnt lgkmcnt(15)
    v_mfma_f32_32x32x16_bf16 v[240:255], a[196:199], v[108:111], v[240:255]
    ds_read_b64_tr_b16 v[88:89], v23 offset:12416
    ds_read_b64_tr_b16 v[90:91], v23 offset:15488
    s_waitcnt lgkmcnt(15)
    v_mfma_f32_32x32x16_bf16 v[208:223], a[200:203], a[176:179], v[208:223]
    ds_read_b64_tr_b16 v[92:93], v23 offset:13824
    ds_read_b64_tr_b16 v[94:95], v23 offset:16896
    s_waitcnt lgkmcnt(15)
    v_mfma_f32_32x32x16_bf16 v[224:239], a[200:203], a[180:183], v[224:239]
    s_add_u32 m0, s70, 1024
    s_mov_b32 s67, 0x26000
    buffer_load_dwordx4 v20, s[24:27], s67 offen lds
    ds_read_b64_tr_b16 v[96:97], v23 offset:13888
    ds_read_b64_tr_b16 v[98:99], v23 offset:16960
    s_waitcnt lgkmcnt(15)
    v_mfma_f32_32x32x16_bf16 v[240:255], a[200:203], a[184:187], v[240:255]
    ds_read_b64_tr_b16 v[100:101], v23 offset:13952
    ds_read_b64_tr_b16 v[102:103], v23 offset:17024
    s_waitcnt lgkmcnt(15)
    v_mfma_f32_32x32x16_bf16 v[208:223], a[204:207], a[188:191], v[208:223]
    ds_read_b64_tr_b16 v[104:105], v23 offset:18432
    ds_read_b64_tr_b16 v[106:107], v23 offset:21504
    s_waitcnt lgkmcnt(15)
    v_mfma_f32_32x32x16_bf16 v[224:239], a[204:207], a[224:227], v[224:239]
    ds_read_b64_tr_b16 v[108:109], v23 offset:18496
    ds_read_b64_tr_b16 v[110:111], v23 offset:21568
    s_waitcnt lgkmcnt(15)
    v_mfma_f32_32x32x16_bf16 v[240:255], a[204:207], a[228:231], v[240:255]
    ds_read_b64_tr_b16 a[176:177], v23 offset:18560
    ds_read_b64_tr_b16 a[178:179], v23 offset:21632
    s_waitcnt lgkmcnt(15)
    v_mfma_f32_32x32x16_bf16 v[208:223], a[208:211], a[232:235], v[208:223]
    ds_read_b64_tr_b16 a[180:181], v23 offset:19968
    ds_read_b64_tr_b16 a[182:183], v23 offset:23040
    s_waitcnt lgkmcnt(15)
    v_mfma_f32_32x32x16_bf16 v[224:239], a[208:211], a[236:239], v[224:239]
    buffer_load_dwordx4 v[128:131], v2, s[36:39], s35 offen offset:0 sc1
    buffer_load_dwordx4 v[132:135], v2, s[36:39], s35 offen offset:1024 sc1
    buffer_load_dwordx4 v[136:139], v2, s[36:39], s35 offen offset:2048 sc1
    buffer_load_dwordx4 v[140:143], v2, s[36:39], s35 offen offset:3072 sc1
    buffer_load_dwordx4 v[112:115], v16, s[40:43], s73 offen sc1
    buffer_load_dwordx4 v[116:119], v16, s[40:43], s73 offen offset:512 sc1
    s_waitcnt lgkmcnt(14)
    v_mfma_f32_32x32x16_bf16 v[240:255], a[208:211], v[88:91], v[240:255]
    s_add_u32 m0, s70, 2048
    s_mov_b32 s67, 0x28000
    buffer_load_dwordx4 v20, s[24:27], s67 offen lds
    ds_read_b64_tr_b16 a[184:185], v23 offset:20032
    ds_read_b64_tr_b16 a[186:187], v23 offset:23104
    s_waitcnt lgkmcnt(14)
    v_mfma_f32_32x32x16_bf16 v[208:223], a[212:215], v[92:95], v[208:223]
    ds_read_b64_tr_b16 a[188:189], v23 offset:20096
    ds_read_b64_tr_b16 a[190:191], v23 offset:23168
    ds_read_b64_tr_b16 a[224:225], v14 offset:0
    ds_read_b64_tr_b16 a[226:227], v14 offset:3072
    s_waitcnt lgkmcnt(15)
    v_mfma_f32_32x32x16_bf16 v[224:239], a[212:215], v[96:99], v[224:239]
    ds_read_b64_tr_b16 a[228:229], v14 offset:64
    ds_read_b64_tr_b16 a[230:231], v14 offset:3136
    s_waitcnt lgkmcnt(15)
    v_mfma_f32_32x32x16_bf16 v[240:255], a[212:215], v[100:103], v[240:255]
    ds_read_b64_tr_b16 a[232:233], v14 offset:1536
    ds_read_b64_tr_b16 a[234:235], v14 offset:4608
    s_waitcnt lgkmcnt(15)
    v_mfma_f32_32x32x16_bf16 v[208:223], a[216:219], v[104:107], v[208:223]
    s_add_u32 m0, s70, 3072
    s_mov_b32 s67, 0x2a000
    buffer_load_dwordx4 v20, s[24:27], s67 offen lds
    ds_read_b64_tr_b16 a[236:237], v14 offset:128
    ds_read_b64_tr_b16 a[238:239], v14 offset:3200
    s_waitcnt lgkmcnt(15)
    v_mfma_f32_32x32x16_bf16 v[224:239], a[216:219], v[108:111], v[224:239]
    ds_read_b64_tr_b16 v[88:89], v14 offset:6144
    ds_read_b64_tr_b16 v[90:91], v14 offset:9216
    s_waitcnt lgkmcnt(15)
    v_mfma_f32_32x32x16_bf16 v[240:255], a[216:219], a[176:179], v[240:255]
    ds_read_b64_tr_b16 v[92:93], v14 offset:1600
    ds_read_b64_tr_b16 v[94:95], v14 offset:4672
    s_waitcnt lgkmcnt(15)
    v_mfma_f32_32x32x16_bf16 v[208:223], a[220:223], a[180:183], v[208:223]
    s_add_u32 m0, s70, 4096
    s_mov_b32 s67, 0x2c000
    buffer_load_dwordx4 v20, s[24:27], s67 offen lds
    ds_read_b64_tr_b16 v[96:97], v14 offset:1664
    ds_read_b64_tr_b16 v[98:99], v14 offset:4736
    s_waitcnt lgkmcnt(15)
    v_mfma_f32_32x32x16_bf16 v[224:239], a[220:223], a[184:187], v[224:239]
    ds_read_b64_tr_b16 v[100:101], v14 offset:7680
    ds_read_b64_tr_b16 v[102:103], v14 offset:10752
    s_waitcnt lgkmcnt(15)
    v_mfma_f32_32x32x16_bf16 v[240:255], a[220:223], a[188:191], v[240:255]
    s_mov_b32 s66, 0x4e20
    s_waitcnt vmcnt(3)
    s_nop 8
L_chk_27:
    v_max3_u32 v124, v112, v113, v114
    v_max3_u32 v124, v124, v115, v116
    v_max3_u32 v124, v124, v117, v118
    v_max3_u32 v124, v124, v119, v128
    v_max3_u32 v124, v124, v132, v136
    v_max3_u32 v124, v124, v140, v140
    v_cmp_eq_u32 vcc, -1, v124
    s_cmp_lg_u64 vcc, 0
    s_cbranch_scc0 L_ok_28
    s_sub_u32 s66, s66, 1
    s_cbranch_scc1 L_ok_28
    s_sub_u32 s35, s35, 0
    buffer_load_dwordx4 v[128:131], v2, s[36:39], s35 offen offset:0 sc1
    buffer_load_dwordx4 v[132:135], v2, s[36:39], s35 offen offset:1024 sc1
    buffer_load_dwordx4 v[136:139], v2, s[36:39], s35 offen offset:2048 sc1
    buffer_load_dwordx4 v[140:143], v2, s[36:39], s35 offen offset:3072 sc1
    buffer_load_dwordx4 v[112:115], v16, s[40:43], s73 offen sc1
    buffer_load_dwordx4 v[116:119], v16, s[40:43], s73 offen offset:512 sc1
    s_waitcnt vmcnt(0)
    s_branch L_chk_27
L_ok_28:
    s_add_u32 s35, s35, 4096
    buffer_load_dwordx4 v[144:147], v2, s[36:39], s35 offen offset:0 sc1
    buffer_load_dwordx4 v[148:151], v2, s[36:39], s35 offen offset:1024 sc1
    s_waitcnt lgkmcnt(14)
    v_mfma_f32_32x32x16_bf16 v[40:55], a[224:227], v[128:131], 0
    buffer_load_dwordx4 v[152:155], v2, s[36:39], s35 offen offset:2048 sc1
    ds_read_b64_tr_b16 v[104:105], v14 offset:6208
    ds_read_b64_tr_b16 v[106:107], v14 offset:9280
    v_add_f32 v112, v112, v114
    ds_write_b32 v17, v208 offset:0
    ds_write_b32 v17, v224 offset:256
    s_waitcnt lgkmcnt(15)
    v_mfma_f32_32x32x16_bf16 v[56:71], a[228:231], v[128:131], 0
    v_add_f32 v116, v116, v118
    ds_read_b64_tr_b16 v[108:109], v14 offset:12288
    ds_read_b64_tr_b16 v[110:111], v14 offset:15360
    ds_read_b64_tr_b16 a[72:73], v21 offset:0
    ds_read_b64_tr_b16 a[76:77], v22 offset:0
    ds_write_b32 v17, v240 offset:512
    s_waitcnt lgkmcnt(15)
    v_mfma_f32_32x32x16_bf16 v[40:55], a[232:235], v[132:135], v[40:55]
    v_add_f32 v113, v113, v115
    ds_read_b64_tr_b16 a[74:75], v21 offset:1024
    ds_read_b64_tr_b16 a[78:79], v22 offset:1024
    v_add_f32 v117, v117, v119
    s_waitcnt lgkmcnt(15)
    v_mfma_f32_32x32x16_bf16 v[72:87], a[236:239], v[128:131], 0
    buffer_load_dwordx4 v[156:159], v2, s[36:39], s35 offen offset:3072 sc1
    ds_read_b64_tr_b16 a[176:177], v14 offset:6272
    ds_read_b64_tr_b16 a[178:179], v14 offset:9344
    v_add_f32 v114, v112, v116
    ds_read_b64_tr_b16 a[180:181], v14 offset:13824
    ds_read_b64_tr_b16 a[182:183], v14 offset:16896
    s_waitcnt lgkmcnt(15)
    v_mfma_f32_32x32x16_bf16 v[40:55], v[88:91], v[136:139], v[40:55]
    s_add_u32 s35, s35, 4096
    buffer_load_dwordx4 v[160:163], v2, s[36:39], s35 offen offset:0 sc1
    v_add_f32 v115, v113, v117
    ds_read_b64_tr_b16 a[184:185], v14 offset:7744
    ds_read_b64_tr_b16 a[186:187], v14 offset:10816
    v_add_f32 v112, v112, v116
    s_waitcnt lgkmcnt(15)
    v_mfma_f32_32x32x16_bf16 v[56:71], v[92:95], v[132:135], v[56:71]
    ds_read_b64_tr_b16 a[188:189], v14 offset:7808
    ds_read_b64_tr_b16 a[190:191], v14 offset:10880
    v_add_f32 v113, v113, v117
    v_mov_b32 v116, 0x3727c5ac
    ds_read_b64_tr_b16 a[224:225], v14 offset:18432
    ds_read_b64_tr_b16 a[226:227], v14 offset:21504
    v_permlane32_swap_b32 v112, v114
    s_waitcnt lgkmcnt(15)
    v_mfma_f32_32x32x16_bf16 v[72:87], v[96:99], v[132:135], v[72:87]
    buffer_load_dwordx4 v[164:167], v2, s[36:39], s35 offen offset:1024 sc1
    ds_read_b64_tr_b16 a[228:229], v14 offset:12352
    ds_read_b64_tr_b16 a[230:231], v14 offset:15424
    s_waitcnt lgkmcnt(14)
    s_barrier
    v_mfma_f32_32x32x16_bf16 v[40:55], v[100:103], v[140:143], v[40:55]
    ds_read_b32 v209, v7 offset:0
    ds_read_b32 v210, v7 offset:256
    v_permlane32_swap_b32 v113, v115
    ds_read_b32 v211, v7 offset:512
    ds_read_b64_tr_b16 a[232:233], v14 offset:19968
    ds_read_b64_tr_b16 a[234:235], v14 offset:23040
    v_mfma_f32_32x32x16_bf16 v[56:71], v[104:107], v[136:139], v[56:71]
    buffer_load_dwordx4 v[168:171], v2, s[36:39], s35 offen offset:2048 sc1
    ds_read_b32 v212, v7 offset:768
    ds_read_b32 v213, v7 offset:1024
    ds_read_b64_tr_b16 a[236:237], v14 offset:12416
    ds_read_b64_tr_b16 a[238:239], v14 offset:15488
    v_add_f32 v112, v112, v114
    s_waitcnt vmcnt(6)
    v_mfma_f32_32x32x16_bf16 v[40:55], v[108:111], v[144:147], v[40:55]
    ds_read_b32 v214, v7 offset:1280
    ds_read_b32 v215, v7 offset:1536
    ds_read_b64_tr_b16 v[88:89], v14 offset:24576
    ds_read_b64_tr_b16 v[90:91], v14 offset:27648
    v_add_f32 v113, v113, v115
    ds_read_b32 v216, v7 offset:1792
    s_waitcnt lgkmcnt(15)
    v_mfma_f32_32x32x16_bf16 v[72:87], a[176:179], v[136:139], v[72:87]
    buffer_load_dwordx4 v[172:175], v2, s[36:39], s35 offen offset:3072 sc1
    v_mul_f32 v112, 0x3b000000, v112
    ds_read_b32 v217, v7 offset:2048
    ds_read_b64_tr_b16 v[92:93], v14 offset:13888
    ds_read_b64_tr_b16 v[94:95], v14 offset:16960
    ds_read_b32 v218, v7 offset:2304
    s_waitcnt vmcnt(6) lgkmcnt(15)
    v_mfma_f32_32x32x16_bf16 v[40:55], a[180:183], v[148:151], v[40:55]
    v_max3_u32 v124, v124, v144, v148
    v_fmac_f32 v116, 0x3b000000, v113
    ds_read_b32 v219, v7 offset:2560
    ds_read_b64_tr_b16 v[96:97], v14 offset:26112
    ds_read_b64_tr_b16 v[98:99], v14 offset:29184
    ds_read_b32 v220, v7 offset:2816
    v_fma_f32 v113, -v112, v112, v116
    s_waitcnt lgkmcnt(15)
    v_mfma_f32_32x32x16_bf16 v[56:71], a[184:187], v[140:143], v[56:71]
    s_add_u32 s35, s35, 4096
    buffer_load_dwordx4 v[176:179], v2, s[36:39], s35 offen offset:0 sc1
    s_waitcnt lgkmcnt(15)
    v_add_f32 v209, v209, v212
    v_max_f32 v113, 0x3727c5ac, v113
    s_waitcnt lgkmcnt(4)
    v_add_f32 v215, v215, v218
    v_mfma_f32_32x32x16_bf16 v[72:87], a[188:191], v[140:143], v[72:87]
    ds_read_b64_tr_b16 v[100:101], v14 offset:13952
    ds_read_b64_tr_b16 v[102:103], v14 offset:17024
    v_add_f32 v120, v209, v215
    v_sqrt_f32 v113, v113
    v_add_f32 v210, v210, v213
    s_waitcnt vmcnt(6)
    v_mfma_f32_32x32x16_bf16 v[40:55], a[224:227], v[152:155], v[40:55]
    buffer_load_dwordx4 v[180:183], v2, s[36:39], s35 offen offset:1024 sc1
    ds_read_b64_tr_b16 v[104:105], v14 offset:30720
    ds_read_b64_tr_b16 v[106:107], v14 offset:33792
    s_waitcnt lgkmcnt(7)
    v_add_f32 v216, v216, v219
    v_add_f32 v121, v210, v216
    v_mfma_f32_32x32x16_bf16 v[56:71], a[228:231], v[144:147], v[56:71]
    buffer_load_dwordx4 v[184:187], v2, s[36:39], s35 offen offset:2048 sc1
    ds_read_b64_tr_b16 v[108:109], v14 offset:18496
    ds_read_b64_tr_b16 v[110:111], v14 offset:21568
    ds_read_b64_tr_b16 a[80:81], v21 offset:2048
    ds_read_b64_tr_b16 a[84:85], v22 offset:2048
    s_waitcnt vmcnt(7)
    v_mfma_f32_32x32x16_bf16 v[40:55], a[232:235], v[156:159], v[40:55]
    v_cmp_gt_u32 vcc, 32, v1
    v_sub_f32 v112, 0, v112
    s_nop 0
    v_cndmask_b32 v123, v112, v113, vcc
    v_add_f32 v211, v211, v214
    v_max3_u32 v124, v124, v152, v156
    v_mfma_f32_32x32x16_bf16 v[72:87], a[236:239], v[144:147], v[72:87]
    ds_read_b64_tr_b16 a[82:83], v21 offset:3072
    ds_read_b64_tr_b16 a[86:87], v22 offset:3072
    ds_read_b64_tr_b16 a[176:177], v14 offset:18560
    ds_read_b64_tr_b16 a[178:179], v14 offset:21632
    s_waitcnt lgkmcnt(12)
    v_add_f32 v217, v217, v220
    s_waitcnt vmcnt(6)
    v_mfma_f32_32x32x16_bf16 v[40:55], v[88:91], v[160:163], v[40:55]
    buffer_load_dwordx4 v[188:191], v2, s[36:39], s35 offen offset:3072 sc1
    ds_read_b64_tr_b16 a[88:89], v21 offset:4096
    ds_read_b64_tr_b16 a[92:93], v22 offset:4096
    v_add_f32 v122, v211, v217
    v_mfma_f32_32x32x16_bf16 v[56:71], v[92:95], v[148:151], v[56:71]
    s_add_u32 s35, s35, 4096
    buffer_load_dwordx4 v[192:195], v2, s[36:39], s35 offen offset:0 sc1
    ds_read_b64_tr_b16 a[180:181], v14 offset:32256
    ds_read_b64_tr_b16 a[182:183], v14 offset:35328
    ds_read_b64_tr_b16 a[184:185], v14 offset:20032
    ds_read_b64_tr_b16 a[186:187], v14 offset:23104
    s_waitcnt vmcnt(7)
    v_mfma_f32_32x32x16_bf16 v[40:55], v[96:99], v[164:167], v[40:55]
    ds_read_b64_tr_b16 a[188:189], v14 offset:36864
    ds_read_b64_tr_b16 a[190:191], v14 offset:39936
    v_cvt_pk_bf16_f32 v112, v120, v120
    v_cvt_pk_bf16_f32 v114, v121, v121
    v_max3_u32 v124, v124, v160, v164
    s_waitcnt lgkmcnt(15)
    v_mfma_f32_32x32x16_bf16 v[72:87], v[100:103], v[148:151], v[72:87]
    buffer_load_dwordx4 v[196:199], v2, s[36:39], s35 offen offset:1024 sc1
    ds_read_b64_tr_b16 a[224:225], v14 offset:20096
    ds_read_b64_tr_b16 a[226:227], v14 offset:23168
    v_cvt_pk_bf16_f32 v116, v122, v122
    v_cvt_pk_bf16_f32 v118, v123, v123
    s_waitcnt vmcnt(7) lgkmcnt(15)
    v_mfma_f32_32x32x16_bf16 v[40:55], v[104:107], v[168:171], v[40:55]
    ds_read_b64_tr_b16 a[228:229], v14 offset:38400
    ds_read_b64_tr_b16 a[230:231], v14 offset:41472
    v_and_b32 v113, 0xffff0000, v112
    v_and_b32 v115, 0xffff0000, v114
    ds_read_b64_tr_b16 a[232:233], v14 offset:24640
    ds_read_b64_tr_b16 a[234:235], v14 offset:27712
    s_waitcnt lgkmcnt(15)
    v_mfma_f32_32x32x16_bf16 v[56:71], v[108:111], v[152:155], v[56:71]
    buffer_load_dwordx4 v[200:203], v2, s[36:39], s35 offen offset:2048 sc1
    v_and_b32 v117, 0xffff0000, v116
    v_and_b32 v119, 0xffff0000, v118
    v_sub_f32 v113, v120, v113
    s_waitcnt lgkmcnt(14)
    v_mfma_f32_32x32x16_bf16 v[72:87], a[176:179], v[152:155], v[72:87]
    ds_read_b64_tr_b16 a[236:237], v14 offset:24704
    ds_read_b64_tr_b16 a[238:239], v14 offset:27776
    v_sub_f32 v115, v121, v115
    ds_read_b64_tr_b16 v[88:89], v14 offset:43008
    ds_read_b64_tr_b16 v[90:91], v14 offset:46080
    v_sub_f32 v117, v122, v117
    s_waitcnt vmcnt(7) lgkmcnt(14)
    v_mfma_f32_32x32x16_bf16 v[40:55], a[180:183], v[172:175], v[40:55]
    buffer_load_dwordx4 v[204:207], v2, s[36:39], s35 offen offset:3072 sc1
    v_sub_f32 v119, v123, v119
    ds_read_b64_tr_b16 v[92:93], v14 offset:26176
    ds_read_b64_tr_b16 v[94:95], v14 offset:29248
    v_max3_u32 v124, v124, v168, v172
    s_waitcnt lgkmcnt(14)
    v_mfma_f32_32x32x16_bf16 v[56:71], a[184:187], v[156:159], v[56:71]
    v_cvt_pk_bf16_f32 v113, v113, v113
    v_cvt_pk_bf16_f32 v115, v115, v115
    ds_read_b64_tr_b16 v[96:97], v14 offset:44544
    ds_read_b64_tr_b16 v[98:99], v14 offset:47616
    v_cvt_pk_bf16_f32 v117, v117, v117
    v_cvt_pk_bf16_f32 v118, v123, v119
    s_waitcnt vmcnt(7) lgkmcnt(14)
    v_mfma_f32_32x32x16_bf16 v[40:55], a[188:191], v[176:179], v[40:55]
    s_add_u32 s35, s35, 4096
    buffer_load_dwordx4 v[208:211], v2, s[36:39], s35 offen offset:0 sc1
    ds_read_b64_tr_b16 v[100:101], v14 offset:26240
    ds_read_b64_tr_b16 v[102:103], v14 offset:29312
    v_mov_b32 v119, v118
    s_waitcnt lgkmcnt(14)
    v_mfma_f32_32x32x16_bf16 v[72:87], a[224:227], v[156:159], v[72:87]
    ds_read_b64_tr_b16 v[104:105], v15 offset:0
    ds_read_b64_tr_b16 v[106:107], v15 offset:3072
    ds_read_b64_tr_b16 v[108:109], v14 offset:30784
    ds_read_b64_tr_b16 v[110:111], v14 offset:33856
    s_waitcnt vmcnt(7) lgkmcnt(15)
    v_mfma_f32_32x32x16_bf16 v[40:55], a[228:231], v[180:183], v[40:55]
    buffer_load_dwordx4 v[212:215], v2, s[36:39], s35 offen offset:1024 sc1
    v_max3_u32 v124, v124, v176, v180
    ds_read_b64_tr_b16 a[176:177], v15 offset:1536
    ds_read_b64_tr_b16 a[178:179], v15 offset:4608
    s_waitcnt lgkmcnt(15)
    v_mfma_f32_32x32x16_bf16 v[56:71], a[232:235], v[160:163], v[56:71]
    buffer_load_dwordx4 v[216:219], v2, s[36:39], s35 offen offset:2048 sc1
    s_lshl_b32 s55, s49, 1
    s_lshr_b32 s56, s46, 1
    ds_read_b64_tr_b16 a[180:181], v14 offset:30848
    ds_read_b64_tr_b16 a[182:183], v14 offset:33920
    v_mfma_f32_32x32x8_bf16 v[40:55], v[112:113], v[118:119], v[40:55]
    s_waitcnt lgkmcnt(15)
    v_mfma_f32_32x32x16_bf16 v[72:87], a[236:239], v[160:163], v[72:87]
    s_add_u32 s55, s55, s56
    ds_read_b64_tr_b16 a[184:185], v15 offset:6144
    ds_read_b64_tr_b16 a[186:187], v15 offset:9216
    s_waitcnt vmcnt(8) lgkmcnt(15)
    v_mfma_f32_32x32x16_bf16 v[40:55], v[88:91], v[184:187], v[40:55]
    buffer_load_dwordx4 v[220:223], v2, s[36:39], s35 offen offset:3072 sc1
    s_lshl_b32 s31, s55, 11
    ds_read_b64_tr_b16 a[188:189], v14 offset:32320
    ds_read_b64_tr_b16 a[190:191], v14 offset:35392
    s_waitcnt lgkmcnt(15)
    v_mfma_f32_32x32x16_bf16 v[56:71], v[92:95], v[164:167], v[56:71]
    s_add_u32 s31, s31, 131072
    ds_read_b64_tr_b16 a[224:225], v14 offset:32384
    ds_read_b64_tr_b16 a[226:227], v14 offset:35456
    s_waitcnt vmcnt(8) lgkmcnt(15)
    v_mfma_f32_32x32x16_bf16 v[40:55], v[96:99], v[188:191], v[40:55]
    s_add_u32 s35, s35, 4096
    buffer_load_dwordx4 v[224:227], v2, s[36:39], s35 offen offset:0 sc1
    v_max3_u32 v124, v124, v184, v188
    s_xor_b32 s56, s55, 1
    v_mfma_f32_32x32x8_bf16 v[56:71], v[114:115], v[118:119], v[56:71]
    s_waitcnt lgkmcnt(14)
    v_mfma_f32_32x32x16_bf16 v[72:87], v[100:103], v[164:167], v[72:87]
    ds_read_b64_tr_b16 a[228:229], v15 offset:7680
    ds_read_b64_tr_b16 a[230:231], v15 offset:10752
    s_mul_i32 s28, s56, 88064
    ds_read_b64_tr_b16 a[232:233], v14 offset:36928
    ds_read_b64_tr_b16 a[234:235], v14 offset:40000
    s_waitcnt vmcnt(8) lgkmcnt(15)
    v_mfma_f32_32x32x16_bf16 v[40:55], v[104:107], v[192:195], v[40:55]
    buffer_load_dwordx4 v[228:231], v2, s[36:39], s35 offen offset:1024 sc1
    s_mul_i32 s29, s55, 88064
    ds_read_b64_tr_b16 a[236:237], v15 offset:12288
    ds_read_b64_tr_b16 a[238:239], v15 offset:15360
    s_mul_i32 s56, s46, 22528
    v_mfma_f32_32x32x8_bf16 v[72:87], v[116:117], v[118:119], v[72:87]
    s_waitcnt lgkmcnt(15)
    v_mfma_f32_32x32x16_bf16 v[56:71], v[108:111], v[168:171], v[56:71]
    ds_read_b64_tr_b16 v[88:89], v14 offset:36992
    ds_read_b64_tr_b16 v[90:91], v14 offset:40064
    s_add_u32 s56, s56, 6160384
    s_waitcnt vmcnt(8) lgkmcnt(15)
    v_mfma_f32_32x32x16_bf16 v[40:55], a[176:179], v[196:199], v[40:55]
    buffer_load_dwordx4 v[232:235], v2, s[36:39], s35 offen offset:2048 sc1
    v_max3_u32 v124, v124, v192, v196
    ds_read_b64_tr_b16 v[92:93], v15 offset:13824
    ds_read_b64_tr_b16 v[94:95], v15 offset:16896
    s_add_u32 s28, s28, s56
    s_waitcnt lgkmcnt(15)
    v_mfma_f32_32x32x16_bf16 v[72:87], a[180:183], v[168:171], v[72:87]
    ds_read_b64_tr_b16 v[96:97], v14 offset:38464
    ds_read_b64_tr_b16 v[98:99], v14 offset:41536
    s_add_u32 s29, s29, s56
    s_waitcnt vmcnt(8) lgkmcnt(15)
    v_mfma_f32_32x32x16_bf16 v[40:55], a[184:187], v[200:203], v[40:55]
    buffer_load_dwordx4 v[236:239], v2, s[36:39], s35 offen offset:3072 sc1
    ds_read_b64_tr_b16 v[100:101], v14 offset:38528
    ds_read_b64_tr_b16 v[102:103], v14 offset:41600
    s_mov_b32 s30, 0x1000
    s_waitcnt lgkmcnt(15)
    v_mfma_f32_32x32x16_bf16 v[56:71], a[188:191], v[172:175], v[56:71]
    ds_read_b64_tr_b16 v[104:105], v15 offset:18432
    ds_read_b64_tr_b16 v[106:107], v15 offset:21504
    s_cmp_eq_u32 s46, 3
    s_cselect_b32 s30, 0x40000000, s30
    s_waitcnt lgkmcnt(15)
    v_mfma_f32_32x32x16_bf16 v[72:87], a[224:227], v[172:175], v[72:87]
    s_add_u32 s35, s35, 4096
    buffer_load_dwordx4 v[240:243], v2, s[36:39], s35 offen offset:0 sc1
    ds_read_b64_tr_b16 v[108:109], v14 offset:43072
    ds_read_b64_tr_b16 v[110:111], v14 offset:46144
    s_waitcnt vmcnt(9) lgkmcnt(15)
    v_mfma_f32_32x32x16_bf16 v[40:55], a[228:231], v[204:207], v[40:55]
    v_max3_u32 v124, v124, v200, v204
    ds_read_b64_tr_b16 a[176:177], v15 offset:19968
    ds_read_b64_tr_b16 a[178:179], v15 offset:23040
    s_mul_i32 s55, s46, 11
    s_waitcnt lgkmcnt(15)
    v_mfma_f32_32x32x16_bf16 v[56:71], a[232:235], v[176:179], v[56:71]
    buffer_load_dwordx4 v[244:247], v2, s[36:39], s35 offen offset:1024 sc1
    ds_read_b64_tr_b16 a[180:181], v14 offset:43136
    ds_read_b64_tr_b16 a[182:183], v14 offset:46208
    v_and_b32 v12, 0x3c, v1
    s_waitcnt vmcnt(9) lgkmcnt(15)
    v_mfma_f32_32x32x16_bf16 v[40:55], a[236:239], v[208:211], v[40:55]
    buffer_load_dwordx4 v[248:251], v2, s[36:39], s35 offen offset:2048 sc1
    s_mov_b32 s56, 0x7654e210
    ds_read_b64_tr_b16 a[184:185], v15 offset:24576
    ds_read_b64_tr_b16 a[186:187], v15 offset:27648
    s_waitcnt lgkmcnt(15)
    v_mfma_f32_32x32x16_bf16 v[72:87], v[88:91], v[176:179], v[72:87]
    s_mov_b32 s57, 0xb3dcfa98
    ds_read_b64_tr_b16 a[188:189], v14 offset:44608
    ds_read_b64_tr_b16 a[190:191], v14 offset:47680
    s_waitcnt vmcnt(9) lgkmcnt(15)
    v_mfma_f32_32x32x16_bf16 v[40:55], v[92:95], v[212:215], v[40:55]
    buffer_load_dwordx4 v[252:255], v2, s[36:39], s35 offen offset:3072 sc1
    v_max3_u32 v124, v124, v208, v212
    v_lshrrev_b64 v[12:13], v12, s[56:57]
    ds_read_b64_tr_b16 a[224:225], v15 offset:26112
    ds_read_b64_tr_b16 a[226:227], v15 offset:29184
    s_waitcnt lgkmcnt(15)
    v_mfma_f32_32x32x16_bf16 v[56:71], v[96:99], v[180:183], v[56:71]
    v_and_b32 v12, 15, v12
    ds_read_b64_tr_b16 a[228:229], v14 offset:44672
    ds_read_b64_tr_b16 a[230:231], v14 offset:47744
    s_waitcnt lgkmcnt(15)
    v_mfma_f32_32x32x16_bf16 v[72:87], v[100:103], v[180:183], v[72:87]
    s_add_u32 m0, s70, 5120
    s_mov_b32 s67, 0x2e000
    buffer_load_dwordx4 v20, s[24:27], s67 offen lds
    v_mul_u32_u24 v12, 3, v12
    ds_read_b64_tr_b16 a[232:233], v15 offset:30720
    ds_read_b64_tr_b16 a[234:235], v15 offset:33792
    s_waitcnt vmcnt(10) lgkmcnt(15)
    v_mfma_f32_32x32x16_bf16 v[40:55], v[104:107], v[216:219], v[40:55]
    v_add_u32 v13, 2, v12
    ds_read_b64_tr_b16 a[236:237], v15 offset:64
    ds_read_b64_tr_b16 a[238:239], v15 offset:3136
    s_waitcnt lgkmcnt(15)
    v_mfma_f32_32x32x16_bf16 v[56:71], v[108:111], v[184:187], v[56:71]
    s_add_u32 m0, s70, 6144
    s_mov_b32 s67, 0x30000
    buffer_load_dwordx4 v20, s[24:27], s67 offen lds
    v_cmp_le_u32 s[62:63], s55, v13
    ds_read_b64_tr_b16 v[88:89], v15 offset:128
    ds_read_b64_tr_b16 v[90:91], v15 offset:3200
    s_waitcnt vmcnt(10) lgkmcnt(15)
    v_mfma_f32_32x32x16_bf16 v[40:55], a[176:179], v[220:223], v[40:55]
    v_max3_u32 v124, v124, v216, v220
    s_add_u32 s55, s55, 10
    ds_read_b64_tr_b16 v[92:93], v15 offset:32256
    ds_read_b64_tr_b16 v[94:95], v15 offset:35328
    s_min_u32 s55, s55, 42
    s_waitcnt lgkmcnt(15)
    v_mfma_f32_32x32x16_bf16 v[72:87], a[180:183], v[184:187], v[72:87]
    s_add_u32 m0, s70, 7168
    s_mov_b32 s67, 0x32000
    buffer_load_dwordx4 v20, s[24:27], s67 offen lds
    ds_read_b64_tr_b16 v[96:97], v15 offset:1600
    ds_read_b64_tr_b16 v[98:99], v15 offset:4672
    v_cmp_ge_u32 s[64:65], s55, v12
    s_waitcnt vmcnt(10) lgkmcnt(15)
    v_mfma_f32_32x32x16_bf16 v[40:55], a[184:187], v[224:227], v[40:55]
    ds_read_b64_tr_b16 v[100:101], v15 offset:36864
    ds_read_b64_tr_b16 v[102:103], v15 offset:39936
    v_bfe_u32 v12, v1, 1, 1
    s_waitcnt lgkmcnt(15)
    v_mfma_f32_32x32x16_bf16 v[56:71], a[188:191], v[188:191], v[56:71]
    s_add_u32 m0, s70, 8192
    s_mov_b32 s67, 0x34000
    buffer_load_dwordx4 v20, s[24:27], s67 offen lds
    ds_read_b64_tr_b16 v[104:105], v15 offset:1664
    ds_read_b64_tr_b16 v[106:107], v15 offset:4736
    s_and_b32 s55, s49, 1
    s_waitcnt vmcnt(10) lgkmcnt(15)
    v_mfma_f32_32x32x16_bf16 v[40:55], a[224:227], v[228:231], v[40:55]
    v_max3_u32 v124, v124, v224, v228
    ds_read_b64_tr_b16 v[108:109], v15 offset:38400
    ds_read_b64_tr_b16 v[110:111], v15 offset:41472
    v_cmp_eq_u32 s[60:61], s55, v12
    s_waitcnt lgkmcnt(15)
    v_mfma_f32_32x32x16_bf16 v[72:87], a[228:231], v[188:191], v[72:87]
    s_add_u32 m0, s70, 9216
    s_mov_b32 s67, 0x36000
    buffer_load_dwordx4 v20, s[24:27], s67 offen lds
    ds_read_b64_tr_b16 a[176:177], v15 offset:6208
    ds_read_b64_tr_b16 a[178:179], v15 offset:9280
    s_and_b64 s[62:63], s[62:63], s[64:65]
    s_waitcnt vmcnt(10) lgkmcnt(15)
    v_mfma_f32_32x32x16_bf16 v[40:55], a[232:235], v[232:235], v[40:55]
    ds_read_b64_tr_b16 a[180:181], v15 offset:6272
    ds_read_b64_tr_b16 a[182:183], v15 offset:9344
    s_and_b64 s[62:63], s[62:63], s[60:61]
    s_waitcnt lgkmcnt(15)
    v_mfma_f32_32x32x16_bf16 v[56:71], a[236:239], v[192:195], v[56:71]
    s_add_u32 m0, s70, 10240
    s_mov_b32 s67, 0x38000
    buffer_load_dwordx4 v20, s[24:27], s67 offen lds
    ds_read_b64_tr_b16 a[184:185], v15 offset:43008
    ds_read_b64_tr_b16 a[186:187], v15 offset:46080
    s_waitcnt lgkmcnt(15)
    v_mfma_f32_32x32x16_bf16 v[72:87], v[88:91], v[192:195], v[72:87]
    s_add_u32 m0, s70, 11264
    s_mov_b32 s67, 0x3a000
    buffer_load_dwordx4 v20, s[24:27], s67 offen lds
    ds_read_b64_tr_b16 a[188:189], v15 offset:7744
    ds_read_b64_tr_b16 a[190:191], v15 offset:10816
    s_waitcnt vmcnt(11) lgkmcnt(15)
    v_mfma_f32_32x32x16_bf16 v[40:55], v[92:95], v[236:239], v[40:55]
    v_max3_u32 v124, v124, v232, v236
    ds_read_b64_tr_b16 a[224:225], v15 offset:44544
    ds_read_b64_tr_b16 a[226:227], v15 offset:47616
    s_waitcnt lgkmcnt(15)
    v_mfma_f32_32x32x16_bf16 v[56:71], v[96:99], v[196:199], v[56:71]
    s_add_u32 m0, s70, 12288
    s_mov_b32 s67, 0x3c000
    buffer_load_dwordx4 v20, s[24:27], s67 offen lds
    ds_read_b64_tr_b16 a[228:229], v15 offset:7808
    ds_read_b64_tr_b16 a[230:231], v15 offset:10880
    s_waitcnt vmcnt(11) lgkmcnt(15)
    v_mfma_f32_32x32x16_bf16 v[40:55], v[100:103], v[240:243], v[40:55]
    ds_read_b64_tr_b16 a[232:233], v15 offset:12352
    ds_read_b64_tr_b16 a[234:235], v15 offset:15424
    s_waitcnt lgkmcnt(15)
    v_mfma_f32_32x32x16_bf16 v[72:87], v[104:107], v[196:199], v[72:87]
    s_add_u32 m0, s70, 13312
    s_mov_b32 s67, 0x3e000
    buffer_load_dwordx4 v20, s[24:27], s67 offen lds
    ds_read_b64_tr_b16 a[236:237], v15 offset:13888
    ds_read_b64_tr_b16 a[238:239], v15 offset:16960
    s_waitcnt vmcnt(11) lgkmcnt(15)
    v_mfma_f32_32x32x16_bf16 v[40:55], v[108:111], v[244:247], v[40:55]
    v_max3_u32 v124, v124, v240, v244
    ds_read_b64_tr_b16 v[88:89], v15 offset:18496
    ds_read_b64_tr_b16 v[90:91], v15 offset:21568
    s_waitcnt lgkmcnt(15)
    v_mfma_f32_32x32x16_bf16 v[56:71], a[176:179], v[200:203], v[56:71]
    s_add_u32 m0, s70, 14336
    s_mov_b32 s67, 0x40000
    buffer_load_dwordx4 v20, s[24:27], s67 offen lds
    ds_read_b64_tr_b16 v[92:93], v15 offset:20032
    ds_read_b64_tr_b16 v[94:95], v15 offset:23104
    s_waitcnt lgkmcnt(15)
    v_mfma_f32_32x32x16_bf16 v[72:87], a[180:183], v[200:203], v[72:87]
    ds_read_b64_tr_b16 v[96:97], v15 offset:24640
    ds_read_b64_tr_b16 v[98:99], v15 offset:27712
    s_waitcnt vmcnt(11) lgkmcnt(15)
    v_mfma_f32_32x32x16_bf16 v[40:55], a[184:187], v[248:251], v[40:55]
    s_add_u32 m0, s70, 0
    s_mov_b32 s67, 0x42000
    buffer_load_dwordx4 v20, s[24:27], s67 offen lds
    ds_read_b64_tr_b16 v[100:101], v15 offset:26176
    ds_read_b64_tr_b16 v[102:103], v15 offset:29248
    s_waitcnt lgkmcnt(15)
    v_mfma_f32_32x32x16_bf16 v[56:71], a[188:191], v[204:207], v[56:71]
    ds_read_b64_tr_b16 v[104:105], v15 offset:30784
    ds_read_b64_tr_b16 v[106:107], v15 offset:33856
    s_waitcnt vmcnt(11) lgkmcnt(15)
    v_mfma_f32_32x32x16_bf16 v[40:55], a[224:227], v[252:255], v[40:55]
    v_max3_u32 v124, v124, v248, v252
    ds_read_b64_tr_b16 v[108:109], v15 offset:32320
    ds_read_b64_tr_b16 v[110:111], v15 offset:35392
    v_cmp_eq_u32 vcc, -1, v124
    s_cmp_lg_u64 vcc, 0
    s_cbranch_scc1 L_redo
    s_waitcnt lgkmcnt(15)
    v_mfma_f32_32x32x16_bf16 v[72:87], a[228:231], v[204:207], v[72:87]
    ds_read_b64_tr_b16 a[176:177], v15 offset:36928
    ds_read_b64_tr_b16 a[178:179], v15 offset:40000
    s_waitcnt lgkmcnt(15)
    v_mfma_f32_32x32x16_bf16 v[56:71], a[232:235], v[208:211], v[56:71]
    ds_read_b64_tr_b16 a[180:181], v15 offset:38464
    ds_read_b64_tr_b16 a[182:183], v15 offset:41536
    s_waitcnt lgkmcnt(15)
    v_mfma_f32_32x32x16_bf16 v[56:71], a[236:239], v[212:215], v[56:71]
    v_cvt_pk_bf16_f32 v128, v40, v41
    v_cvt_pk_bf16_f32 v129, v42, v43
    ds_read_b64_tr_b16 a[184:185], v15 offset:43072
    ds_read_b64_tr_b16 a[186:187], v15 offset:46144
    v_cvt_pk_bf16_f32 v130, v44, v45
    s_waitcnt lgkmcnt(15)
    v_mfma_f32_32x32x16_bf16 v[56:71], v[88:91], v[216:219], v[56:71]
    v_cvt_pk_bf16_f32 v131, v46, v47
    ds_read_b64_tr_b16 a[188:189], v15 offset:44608
    ds_read_b64_tr_b16 a[190:191], v15 offset:47680
    v_pk_max_i16 v128, v128, 0
    s_waitcnt lgkmcnt(15)
    v_mfma_f32_32x32x16_bf16 v[56:71], v[92:95], v[220:223], v[56:71]
    ds_read_b64_tr_b16 a[224:225], v15 offset:12416
    ds_read_b64_tr_b16 a[226:227], v15 offset:15488
    v_pk_max_i16 v129, v129, 0
    s_waitcnt lgkmcnt(15)
    v_mfma_f32_32x32x16_bf16 v[56:71], v[96:99], v[224:227], v[56:71]
    v_pk_max_i16 v130, v130, 0
    ds_read_b64_tr_b16 a[228:229], v15 offset:13952
    ds_read_b64_tr_b16 a[230:231], v15 offset:17024
    v_pk_max_i16 v131, v131, 0
    s_waitcnt lgkmcnt(15)
    v_mfma_f32_32x32x16_bf16 v[56:71], v[100:103], v[228:231], v[56:71]
    buffer_store_dwordx4 v[128:131], v2, s[40:43], s32 offen offset:0 sc1
    ds_read_b64_tr_b16 a[232:233], v15 offset:18560
    ds_read_b64_tr_b16 a[234:235], v15 offset:21632
    s_waitcnt lgkmcnt(15)
    v_mfma_f32_32x32x16_bf16 v[56:71], v[104:107], v[232:235], v[56:71]
    ds_read_b64_tr_b16 a[236:237], v15 offset:20096
    ds_read_b64_tr_b16 a[238:239], v15 offset:23168
    v_cvt_pk_bf16_f32 v132, v48, v49
    s_waitcnt lgkmcnt(15)
    v_mfma_f32_32x32x16_bf16 v[56:71], v[108:111], v[236:239], v[56:71]
    v_cvt_pk_bf16_f32 v133, v50, v51
    ds_read_b64_tr_b16 v[88:89], v15 offset:24704
    ds_read_b64_tr_b16 v[90:91], v15 offset:27776
    v_cvt_pk_bf16_f32 v134, v52, v53
    s_waitcnt lgkmcnt(15)
    v_mfma_f32_32x32x16_bf16 v[56:71], a[176:179], v[240:243], v[56:71]
    v_cvt_pk_bf16_f32 v135, v54, v55
    ds_read_b64_tr_b16 v[92:93], v15 offset:26240
    ds_read_b64_tr_b16 v[94:95], v15 offset:29312
    v_pk_max_i16 v132, v132, 0
    s_waitcnt lgkmcnt(15)
    v_mfma_f32_32x32x16_bf16 v[56:71], a[180:183], v[244:247], v[56:71]
    ds_read_b64_tr_b16 v[96:97], v15 offset:30848
    ds_read_b64_tr_b16 v[98:99], v15 offset:33920
    v_pk_max_i16 v133, v133, 0
    s_waitcnt lgkmcnt(15)
    v_mfma_f32_32x32x16_bf16 v[56:71], a[184:187], v[248:251], v[56:71]
    v_pk_max_i16 v134, v134, 0
    ds_read_b64_tr_b16 v[100:101], v15 offset:32384
    ds_read_b64_tr_b16 v[102:103], v15 offset:35456
    v_pk_max_i16 v135, v135, 0
    s_waitcnt lgkmcnt(15)
    v_mfma_f32_32x32x16_bf16 v[56:71], a[188:191], v[252:255], v[56:71]
    buffer_store_dwordx4 v[132:135], v2, s[40:43], s32 offen offset:1024 sc1
    ds_read_b64_tr_b16 v[104:105], v15 offset:36992
    ds_read_b64_tr_b16 v[106:107], v15 offset:40064
    s_waitcnt lgkmcnt(15)
    v_mfma_f32_32x32x16_bf16 v[72:87], a[224:227], v[208:211], v[72:87]
    ds_read_b64_tr_b16 v[108:109], v15 offset:38528
    ds_read_b64_tr_b16 v[110:111], v15 offset:41600
    s_waitcnt lgkmcnt(15)
    v_mfma_f32_32x32x16_bf16 v[72:87], a[228:231], v[212:215], v[72:87]
    ds_read_b64_tr_b16 a[176:177], v15 offset:43136
    ds_read_b64_tr_b16 a[178:179], v15 offset:46208
    s_waitcnt lgkmcnt(15)
    v_mfma_f32_32x32x16_bf16 v[72:87], a[232:235], v[216:219], v[72:87]
    v_cvt_pk_bf16_f32 v136, v56, v57
    v_cvt_pk_bf16_f32 v137, v58, v59
    v_cvt_pk_bf16_f32 v138, v60, v61
    ds_read_b64_tr_b16 a[180:181], v15 offset:44672
    ds_read_b64_tr_b16 a[182:183], v15 offset:47744
    v_cvt_pk_bf16_f32 v139, v62, v63
    s_waitcnt lgkmcnt(15)
    v_mfma_f32_32x32x16_bf16 v[72:87], a[236:239], v[220:223], v[72:87]
    v_pk_max_i16 v136, v136, 0
    v_pk_max_i16 v137, v137, 0
    s_waitcnt lgkmcnt(14)
    v_mfma_f32_32x32x16_bf16 v[72:87], v[88:91], v[224:227], v[72:87]
    v_pk_max_i16 v138, v138, 0
    v_pk_max_i16 v139, v139, 0
    s_waitcnt lgkmcnt(12)
    v_mfma_f32_32x32x16_bf16 v[72:87], v[92:95], v[228:231], v[72:87]
    buffer_store_dwordx4 v[136:139], v2, s[40:43], s33 offen offset:0 sc1
    v_cvt_pk_bf16_f32 v140, v64, v65
    s_waitcnt lgkmcnt(10)
    v_mfma_f32_32x32x16_bf16 v[72:87], v[96:99], v[232:235], v[72:87]
    v_cvt_pk_bf16_f32 v141, v66, v67
    v_cvt_pk_bf16_f32 v142, v68, v69
    s_waitcnt lgkmcnt(8)
    v_mfma_f32_32x32x16_bf16 v[72:87], v[100:103], v[236:239], v[72:87]
    v_cvt_pk_bf16_f32 v143, v70, v71
    v_pk_max_i16 v140, v140, 0
    s_waitcnt lgkmcnt(6)
    v_mfma_f32_32x32x16_bf16 v[72:87], v[104:107], v[240:243], v[72:87]
    v_pk_max_i16 v141, v141, 0
    v_pk_max_i16 v142, v142, 0
    s_waitcnt lgkmcnt(4)
    v_mfma_f32_32x32x16_bf16 v[72:87], v[108:111], v[244:247], v[72:87]
    v_pk_max_i16 v143, v143, 0
    buffer_store_dwordx4 v[140:143], v2, s[40:43], s33 offen offset:1024 sc1
    s_waitcnt lgkmcnt(2)
    v_mfma_f32_32x32x16_bf16 v[72:87], a[176:179], v[248:251], v[72:87]
    s_waitcnt lgkmcnt(0)
    v_mfma_f32_32x32x16_bf16 v[72:87], a[180:183], v[252:255], v[72:87]
    s_nop 11
    v_cvt_pk_bf16_f32 v144, v72, v73
    v_cvt_pk_bf16_f32 v145, v74, v75
    v_cvt_pk_bf16_f32 v146, v76, v77
    v_cvt_pk_bf16_f32 v147, v78, v79
    v_pk_max_i16 v144, v144, 0
    v_pk_max_i16 v145, v145, 0
    v_pk_max_i16 v146, v146, 0
    v_pk_max_i16 v147, v147, 0
    buffer_store_dwordx4 v[144:147], v2, s[40:43], s34 offen offset:0 sc1
    v_cvt_pk_bf16_f32 v148, v80, v81
    v_cvt_pk_bf16_f32 v149, v82, v83
    v_cvt_pk_bf16_f32 v150, v84, v85
    v_cvt_pk_bf16_f32 v151, v86, v87
    v_pk_max_i16 v148, v148, 0
    v_pk_max_i16 v149, v149, 0
    v_pk_max_i16 v150, v150, 0
    v_pk_max_i16 v151, v151, 0
    buffer_store_dwordx4 v[148:151], v2, s[40:43], s34 offen offset:1024 sc1
L_dj:
    s_cmp_eq_u32 s54, 0
    s_cbranch_scc1 L_slow_29
L_join_30:
    s_add_u32 m0, s70, 1024
    s_mov_b32 s67, 0x44000
    buffer_load_dwordx4 v20, s[24:27], s67 offen lds
    s_add_u32 m0, s70, 2048
    s_mov_b32 s67, 0x46000
    buffer_load_dwordx4 v20, s[24:27], s67 offen lds
    s_waitcnt vmcnt(2)
    buffer_store_dwordx2 v[8:9], v6, s[40:43], 0 offen offset:1024
    s_lshl_b32 s55, s2, 2
    s_add_u32 s55, s55, s46
    s_cmp_lg_u32 s55, 352
    s_cbranch_scc1 L_nogen
    s_mov_b32 s66, 0x4e20
    s_mov_b32 s55, 0x5000
L_gen:
    buffer_load_dwordx4 v[160:163], v2, s[40:43], s55 offen offset:0 sc1
    buffer_load_dwordx4 v[164:167], v2, s[40:43], s55 offen offset:1024 sc1
    buffer_load_dwordx4 v[168:171], v2, s[40:43], s55 offen offset:2048 sc1
    buffer_load_dwordx4 v[172:175], v2, s[40:43], s55 offen offset:3072 sc1
    s_waitcnt vmcnt(0)
    v_cmp_ne_u64 vcc, s[44:45], v[162:163]
    v_cmp_ne_u64 s[4:5], s[44:45], v[166:167]
    s_or_b64 vcc, vcc, s[4:5]
    v_cmp_ne_u64 s[4:5], s[44:45], v[170:171]
    s_or_b64 vcc, vcc, s[4:5]
    v_cmp_ne_u64 s[4:5], s[44:45], v[174:175]
    s_or_b64 vcc, vcc, s[4:5]
    s_cbranch_scc0 L_gend
    s_sub_u32 s66, s66, 1
    s_cbranch_scc0 L_gen
L_gend:
    v_lshlrev_b32 v160, 24, v1
    s_mov_b32 s55, 0x4000
    buffer_store_dwordx2 v[8:9], v160, s[40:43], s55 offen sc1
L_nogen:
    s_add_u32 m0, s70, 3072
    s_mov_b32 s67, 0x48000
    buffer_load_dwordx4 v20, s[24:27], s67 offen lds
    s_add_u32 m0, s70, 4096
    s_mov_b32 s67, 0x4a000
    buffer_load_dwordx4 v20, s[24:27], s67 offen lds
    ds_read_b64_tr_b16 a[90:91], v21 offset:5120
    ds_read_b64_tr_b16 a[94:95], v22 offset:5120
    s_waitcnt lgkmcnt(0)
    s_add_u32 m0, s70, 5120
    s_mov_b32 s67, 0x4c000
    buffer_load_dwordx4 v20, s[24:27], s67 offen lds
    ds_read_b64_tr_b16 a[96:97], v21 offset:6144
    ds_read_b64_tr_b16 a[100:101], v22 offset:6144
    s_waitcnt lgkmcnt(0)
    s_add_u32 m0, s70, 6144
    s_mov_b32 s67, 0x4e000
    buffer_load_dwordx4 v20, s[24:27], s67 offen lds
    ds_read_b64_tr_b16 a[98:99], v21 offset:7168
    ds_read_b64_tr_b16 a[102:103], v22 offset:7168
    s_waitcnt lgkmcnt(0)
    s_add_u32 m0, s70, 7168
    s_mov_b32 s67, 0x50000
    buffer_load_dwordx4 v20, s[24:27], s67 offen lds
    ds_read_b64_tr_b16 a[104:105], v21 offset:8192
    ds_read_b64_tr_b16 a[108:109], v22 offset:8192
    s_waitcnt lgkmcnt(0)
    s_add_u32 m0, s70, 8192
    s_mov_b32 s67, 0x52000
    buffer_load_dwordx4 v20, s[24:27], s67 offen lds
    ds_read_b64_tr_b16 a[106:107], v21 offset:9216
    ds_read_b64_tr_b16 a[110:111], v22 offset:9216
    s_waitcnt lgkmcnt(0)
    s_add_u32 m0, s70, 9216
    s_mov_b32 s67, 0x54000
    buffer_load_dwordx4 v20, s[24:27], s67 offen lds
    ds_read_b64_tr_b16 a[112:113], v21 offset:10240
    ds_read_b64_tr_b16 a[116:117], v22 offset:10240
    s_waitcnt lgkmcnt(0)
    s_add_u32 m0, s70, 10240
    s_mov_b32 s67, 0x56000
    buffer_load_dwordx4 v20, s[24:27], s67 offen lds
    ds_read_b64_tr_b16 a[114:115], v21 offset:11264
    ds_read_b64_tr_b16 a[118:119], v22 offset:11264
    ds_read_b64_tr_b16 a[120:121], v21 offset:12288
    ds_read_b64_tr_b16 a[124:125], v22 offset:12288
    ds_read_b64_tr_b16 a[122:123], v21 offset:13312
    ds_read_b64_tr_b16 a[126:127], v22 offset:13312
    ds_read_b64_tr_b16 a[128:129], v21 offset:14336
    ds_read_b64_tr_b16 a[132:133], v22 offset:14336
    s_mov_b64 exec, s[62:63]
    buffer_load_dwordx2 v[4:5], v3, s[40:43], 0 offen offset:1024 sc1
    s_mov_b64 exec, -1
    ds_read_b64_tr_b16 a[130:131], v21 offset:0
    ds_read_b64_tr_b16 a[134:135], v22 offset:0
    s_mov_b32 s66, 0x4e20
    s_waitcnt vmcnt(0)
L_chk_31:
    v_cmp_ne_u64 vcc, s[44:45], v[4:5]
    s_and_b64 vcc, vcc, s[62:63]
    s_cbranch_scc0 L_ok_32
    s_sub_u32 s66, s66, 1
    s_cbranch_scc1 L_ok_32
    s_mov_b64 exec, s[62:63]
    buffer_load_dwordx2 v[4:5], v3, s[40:43], 0 offen offset:1024 sc1
    s_mov_b64 exec, -1
    s_waitcnt vmcnt(0)
    s_branch L_chk_31
L_ok_32:
    buffer_load_dwordx4 v[80:83], v2, s[40:43], s28 offen offset:0 sc1
    buffer_load_dwordx4 v[84:87], v2, s[40:43], s28 offen offset:1024 sc1
    buffer_load_dwordx4 v[88:91], v2, s[40:43], s28 offen offset:2048 sc1
    buffer_load_dwordx4 v[92:95], v2, s[40:43], s28 offen offset:3072 sc1
    s_add_u32 s28, s28, 4096
    buffer_load_dwordx4 v[96:99], v2, s[40:43], s28 offen offset:0 sc1
    buffer_load_dwordx4 v[100:103], v2, s[40:43], s28 offen offset:1024 sc1
    buffer_load_dwordx4 v[104:107], v2, s[40:43], s28 offen offset:2048 sc1
    buffer_load_dwordx4 v[108:111], v2, s[40:43], s28 offen offset:3072 sc1
    s_add_u32 s28, s28, 4096
    buffer_load_dwordx4 v[112:115], v2, s[40:43], s28 offen offset:0 sc1
    buffer_load_dwordx4 v[116:119], v2, s[40:43], s28 offen offset:1024 sc1
    buffer_load_dwordx4 v[56:59], v16, s[40:43], s31 offen sc1
    buffer_load_dwordx4 v[60:63], v16, s[40:43], s31 offen offset:512 sc1
    ds_read_b64_tr_b16 a[136:137], v21 offset:1024
    ds_read_b64_tr_b16 a[140:141], v22 offset:1024
    ds_read_b64_tr_b16 a[138:139], v21 offset:2048
    ds_read_b64_tr_b16 a[142:143], v22 offset:2048
    ds_read_b64_tr_b16 a[144:145], v21 offset:3072
    ds_read_b64_tr_b16 a[148:149], v22 offset:3072
    ds_read_b64_tr_b16 a[146:147], v21 offset:4096
    ds_read_b64_tr_b16 a[150:151], v22 offset:4096
    ds_read_b64_tr_b16 a[152:153], v21 offset:5120
    ds_read_b64_tr_b16 a[156:157], v22 offset:5120
    ds_read_b64_tr_b16 a[154:155], v21 offset:6144
    ds_read_b64_tr_b16 a[158:159], v22 offset:6144
    ds_read_b64_tr_b16 a[160:161], v21 offset:7168
    ds_read_b64_tr_b16 a[164:165], v22 offset:7168
    ds_read_b64_tr_b16 a[162:163], v21 offset:8192
    ds_read_b64_tr_b16 a[166:167], v22 offset:8192
    ds_read_b64_tr_b16 a[168:169], v21 offset:9216
    ds_read_b64_tr_b16 a[172:173], v22 offset:9216
    ds_read_b64_tr_b16 a[170:171], v21 offset:10240
    ds_read_b64_tr_b16 a[174:175], v22 offset:10240
    s_waitcnt vmcnt(11)
    v_mfma_f32_32x32x16_bf16 a[208:223], a[0:3], v[80:83], 0
    buffer_load_dwordx4 v[120:123], v2, s[40:43], s28 offen offset:2048 sc1
    v_mfma_f32_32x32x16_bf16 a[224:239], a[4:7], v[80:83], 0
    s_waitcnt vmcnt(11)
    v_mfma_f32_32x32x16_bf16 a[208:223], a[8:11], v[84:87], a[208:223]
    buffer_load_dwordx4 v[124:127], v2, s[40:43], s28 offen offset:3072 sc1
    s_barrier
    v_mfma_f32_32x32x16_bf16 a[224:239], a[12:15], v[84:87], a[224:239]
    s_lshl_b32 s55, s46, 4
    v_and_b32 v10, 15, v1
    v_add_u32 v10, s55, v10
    v_mul_u32_u24 v10, 272, v10
    v_and_b32 v11, 0x30, v1
    s_waitcnt vmcnt(11)
    v_mfma_f32_32x32x16_bf16 a[208:223], a[16:19], v[88:91], a[208:223]
    s_add_u32 s28, s28, 4096
    buffer_load_dwordx4 v[128:131], v2, s[40:43], s28 offen offset:0 sc1
    v_add_u32 v10, v10, v11
    v_add_u32 v10, 114688, v10
    ds_write_b128 v10, v[24:27] offset:0
    v_mfma_f32_32x32x16_bf16 a[224:239], a[20:23], v[88:91], a[224:239]
    ds_write_b128 v10, v[28:31] offset:64
    s_waitcnt vmcnt(11)
    v_mfma_f32_32x32x16_bf16 a[208:223], a[24:27], v[92:95], a[208:223]
    buffer_load_dwordx4 v[132:135], v2, s[40:43], s28 offen offset:1024 sc1
    ds_write_b128 v10, v[32:35] offset:128
    v_mfma_f32_32x32x16_bf16 a[224:239], a[28:31], v[92:95], a[224:239]
    ds_write_b128 v10, v[36:39] offset:192
    s_lshr_b32 s55, s46, 1
    s_waitcnt vmcnt(11)
    v_mfma_f32_32x32x16_bf16 a[208:223], a[32:35], v[96:99], a[208:223]
    buffer_load_dwordx4 v[136:139], v2, s[40:43], s28 offen offset:2048 sc1
    s_mul_i32 s55, s55, 8704
    s_and_b32 s56, s46, 1
    s_lshl_b32 s56, s56, 7
    v_mfma_f32_32x32x16_bf16 a[224:239], a[36:39], v[96:99], a[224:239]
    s_add_u32 s55, s55, s56
    s_add_u32 s55, s55, 114688
    v_and_b32 v10, 31, v1
    s_waitcnt vmcnt(11)
    v_mfma_f32_32x32x16_bf16 a[208:223], a[40:43], v[100:103], a[208:223]
    buffer_load_dwordx4 v[140:143], v2, s[40:43], s28 offen offset:3072 sc1
    v_mul_u32_u24 v10, 272, v10
    v_lshrrev_b32 v11, 5, v1
    v_lshlrev_b32 v11, 4, v11
    v_mfma_f32_32x32x16_bf16 a[224:239], a[44:47], v[100:103], a[224:239]
    v_add3_u32 v10, v10, v11, s55
    s_waitcnt vmcnt(11)
    v_mfma_f32_32x32x16_bf16 a[208:223], a[48:51], v[104:107], a[208:223]
    s_add_u32 s28, s28, 4096
    buffer_load_dwordx4 v[144:147], v2, s[40:43], s28 offen offset:0 sc1
    v_mfma_f32_32x32x16_bf16 a[224:239], a[52:55], v[104:107], a[224:239]
    s_waitcnt vmcnt(11)
    v_mfma_f32_32x32x16_bf16 a[208:223], a[56:59], v[108:111], a[208:223]
    buffer_load_dwordx4 v[148:151], v2, s[40:43], s28 offen offset:1024 sc1
    s_waitcnt lgkmcnt(0)
    s_barrier
    v_mfma_f32_32x32x16_bf16 a[224:239], a[60:63], v[108:111], a[224:239]
    ds_read_b128 v[40:43], v10 offset:0
    s_waitcnt vmcnt(11)
    v_mfma_f32_32x32x16_bf16 a[208:223], a[64:67], v[112:115], a[208:223]
    buffer_load_dwordx4 v[152:155], v2, s[40:43], s28 offen offset:2048 sc1
    ds_read_b128 v[44:47], v10 offset:32
    v_mfma_f32_32x32x16_bf16 a[224:239], a[68:71], v[112:115], a[224:239]
    ds_read_b128 v[48:51], v10 offset:64
    s_waitcnt vmcnt(11)
    v_mfma_f32_32x32x16_bf16 a[208:223], a[72:75], v[116:119], a[208:223]
    ds_read_b128 v[52:55], v10 offset:96
    buffer_load_dwordx4 v[156:159], v2, s[40:43], s28 offen offset:3072 sc1
    s_xor_b32 s55, s46, 1
    s_mul_i32 s55, s55, 12288
    s_add_u32 s55, s55, 65536
    v_add_u32 v11, s55, v2
    v_mfma_f32_32x32x16_bf16 a[224:239], a[76:79], v[116:119], a[224:239]
    s_xor_b32 s55, s46, 2
    s_mul_i32 s55, s55, 12288
    s_add_u32 s55, s55, 69632
    v_add_u32 v12, s55, v2
    s_xor_b32 s55, s46, 3
    s_mul_i32 s55, s55, 12288
    s_waitcnt vmcnt(9)
    v_mfma_f32_32x32x16_bf16 a[208:223], a[80:83], v[120:123], a[208:223]
    s_add_u32 s28, s28, s30
    buffer_load_dwordx4 v[160:163], v2, s[40:43], s28 offen offset:0 sc1
    s_add_u32 s55, s55, 73728
    v_add_u32 v13, s55, v2
    v_accvgpr_read_b32 v65, a248
    v_mfma_f32_32x32x16_bf16 a[224:239], a[84:87], v[120:123], a[224:239]
    v_lshlrev_b32 v64, 16, v65
    v_and_b32 v65, 0xffff0000, v65
    v_accvgpr_read_b32 v67, a249
    v_lshlrev_b32 v66, 16, v67
    v_and_b32 v67, 0xffff0000, v67
    s_waitcnt vmcnt(9)
    v_mfma_f32_32x32x16_bf16 a[208:223], a[88:91], v[124:127], a[208:223]
    buffer_load_dwordx4 v[164:167], v2, s[40:43], s28 offen offset:1024 sc1
    v_accvgpr_read_b32 v69, a250
    v_lshlrev_b32 v68, 16, v69
    v_and_b32 v69, 0xffff0000, v69
    v_accvgpr_read_b32 v71, a251
    v_mfma_f32_32x32x16_bf16 a[224:239], a[92:95], v[124:127], a[224:239]
    v_lshlrev_b32 v70, 16, v71
    v_and_b32 v71, 0xffff0000, v71
    v_accvgpr_read_b32 v73, a252
    v_lshlrev_b32 v72, 16, v73
    v_and_b32 v73, 0xffff0000, v73
    v_accvgpr_read_b32 v75, a253
    s_waitcnt vmcnt(9)
    v_mfma_f32_32x32x16_bf16 a[208:223], a[96:99], v[128:131], a[208:223]
    buffer_load_dwordx4 v[168:171], v2, s[40:43], s29 offen offset:0 sc1
    v_lshlrev_b32 v74, 16, v75
    v_and_b32 v75, 0xffff0000, v75
    v_accvgpr_read_b32 v77, a254
    v_lshlrev_b32 v76, 16, v77
    v_mfma_f32_32x32x16_bf16 a[224:239], a[100:103], v[128:131], a[224:239]
    v_and_b32 v77, 0xffff0000, v77
    v_accvgpr_read_b32 v79, a255
    v_lshlrev_b32 v78, 16, v79
    v_and_b32 v79, 0xffff0000, v79
    v_add_f32 v56, v56, v58
    s_waitcnt vmcnt(9)
    v_mfma_f32_32x32x16_bf16 a[208:223], a[104:107], v[132:135], a[208:223]
    buffer_load_dwordx4 v[172:175], v2, s[40:43], s29 offen offset:1024 sc1
    v_add_f32 v60, v60, v62
    v_add_f32 v57, v57, v59
    v_add_f32 v61, v61, v63
    v_mfma_f32_32x32x16_bf16 a[224:239], a[108:111], v[132:135], a[224:239]
    v_add_f32 v58, v56, v60
    v_add_f32 v59, v57, v61
    v_add_f32 v56, v56, v60
    v_add_f32 v57, v57, v61
    s_waitcnt vmcnt(9)
    v_mfma_f32_32x32x16_bf16 a[208:223], a[112:115], v[136:139], a[208:223]
    buffer_load_dwordx4 v[176:179], v2, s[40:43], s29 offen offset:2048 sc1
    v_mov_b32 v60, 0x3727c5ac
    v_permlane32_swap_b32 v56, v58
    v_permlane32_swap_b32 v57, v59
    v_mfma_f32_32x32x16_bf16 a[224:239], a[116:119], v[136:139], a[224:239]
    v_add_f32 v56, v56, v58
    v_add_f32 v57, v57, v59
    s_waitcnt vmcnt(9)
    v_mfma_f32_32x32x16_bf16 a[208:223], a[120:123], v[140:143], a[208:223]
    buffer_load_dwordx4 v[180:183], v2, s[40:43], s29 offen offset:3072 sc1
    v_mul_f32 v56, 0x3b000000, v56
    v_fmac_f32 v60, 0x3b000000, v57
    v_fma_f32 v57, -v56, v56, v60
    v_max_f32 v57, 0x3727c5ac, v57
    v_mfma_f32_32x32x16_bf16 a[224:239], a[124:127], v[140:143], a[224:239]
    v_rsq_f32 v56, v57
    s_mul_i32 s55, s46, 12288
    s_waitcnt vmcnt(9)
    v_mfma_f32_32x32x16_bf16 a[208:223], a[128:131], v[144:147], a[208:223]
    s_add_u32 s29, s29, 4096
    buffer_load_dwordx4 v[184:187], v2, s[40:43], s29 offen offset:0 sc1
    s_add_u32 s55, s55, 65536
    v_add_u32 v14, s55, v2
    v_mul_f32 v64, v56, v64
    v_mul_f32 v65, v56, v65
    v_mfma_f32_32x32x16_bf16 a[224:239], a[132:135], v[144:147], a[224:239]
    v_mul_f32 v66, v56, v66
    v_mul_f32 v67, v56, v67
    v_mul_f32 v68, v56, v68
    s_waitcnt vmcnt(9)
    v_mfma_f32_32x32x16_bf16 a[208:223], a[136:139], v[148:151], a[208:223]
    buffer_load_dwordx4 v[188:191], v2, s[40:43], s29 offen offset:1024 sc1
    v_mul_f32 v69, v56, v69
    v_mul_f32 v70, v56, v70
    v_mul_f32 v71, v56, v71
    v_mul_f32 v72, v56, v72
    v_mfma_f32_32x32x16_bf16 a[224:239], a[140:143], v[148:151], a[224:239]
    v_mul_f32 v73, v56, v73
    v_mul_f32 v74, v56, v74
    v_mul_f32 v75, v56, v75
    s_waitcnt vmcnt(9)
    v_mfma_f32_32x32x16_bf16 a[208:223], a[144:147], v[152:155], a[208:223]
    buffer_load_dwordx4 v[192:195], v2, s[40:43], s29 offen offset:2048 sc1
    v_mul_f32 v76, v56, v76
    v_mul_f32 v77, v56, v77
    v_mul_f32 v78, v56, v78
    v_mul_f32 v79, v56, v79
    v_mfma_f32_32x32x16_bf16 a[224:239], a[148:151], v[152:155], a[224:239]
    s_lshl_b32 s55, s49, 16
    s_lshr_b32 s56, s46, 1
    s_lshl_b32 s56, s56, 15
    s_waitcnt vmcnt(9)
    v_mfma_f32_32x32x16_bf16 a[208:223], a[152:155], v[156:159], a[208:223]
    buffer_load_dwordx4 v[196:199], v2, s[40:43], s29 offen offset:3072 sc1
    s_add_u32 s55, s55, s56
    s_lshl_b32 s56, s50, 7
    s_add_u32 s55, s55, s56
    s_and_b32 s56, s46, 1
    v_mfma_f32_32x32x16_bf16 a[224:239], a[156:159], v[156:159], a[224:239]
    s_lshl_b32 s56, s56, 6
    s_add_u32 s74, s55, s56
    v_lshrrev_b32 v16, 2, v1
    s_waitcnt vmcnt(9)
    v_mfma_f32_32x32x16_bf16 a[208:223], a[160:163], v[160:163], a[208:223]
    s_add_u32 s29, s29, 4096
    buffer_load_dwordx4 v[200:203], v2, s[40:43], s29 offen offset:0 sc1
    v_and_b32 v17, 0x30, v2
    v_lshl_add_u32 v15, v16, 10, v17
    s_mul_i32 s55, s46, 2560
    s_add_u32 s55, s55, 137216
    v_mfma_f32_32x32x16_bf16 a[224:239], a[164:167], v[160:163], a[224:239]
    v_mul_u32_u24 v16, 80, v16
    v_add3_u32 v18, v16, v17, s55
    v_add_u32 v16, 16384, v15
    s_waitcnt vmcnt(9)
    v_mfma_f32_32x32x16_bf16 a[208:223], a[168:171], v[164:167], a[208:223]
    buffer_load_dwordx4 v[204:207], v2, s[40:43], s29 offen offset:1024 sc1
    v_and_b32 v17, 31, v1
    v_mul_u32_u24 v17, 80, v17
    v_lshrrev_b32 v19, 5, v1
    v_lshlrev_b32 v19, 3, v19
    v_mfma_f32_32x32x16_bf16 a[224:239], a[172:175], v[164:167], a[224:239]
    v_add3_u32 v17, v17, v19, s55
    s_waitcnt vmcnt(9)
    v_mfma_f32_32x32x16_bf16 a[192:207], a[4:7], v[168:171], 0
    buffer_load_dwordx4 v[208:211], v2, s[40:43], s29 offen offset:2048 sc1
    v_mfma_f32_32x32x16_bf16 v[24:39], a[0:3], v[168:171], 0
    s_waitcnt vmcnt(9)
    v_mfma_f32_32x32x16_bf16 a[192:207], a[12:15], v[172:175], a[192:207]
    buffer_load_dwordx4 v[212:215], v2, s[40:43], s29 offen offset:3072 sc1
    s_waitcnt vmcnt(9)
    v_mfma_f32_32x32x16_bf16 a[192:207], a[20:23], v[176:179], a[192:207]
    s_add_u32 s29, s29, 4096
    buffer_load_dwordx4 v[216:219], v2, s[40:43], s29 offen offset:0 sc1
    ds_write_b128 v12, a[208:211] offset:0
    v_mfma_f32_32x32x16_bf16 v[24:39], a[8:11], v[172:175], v[24:39]
    ds_write_b128 v12, a[212:215] offset:1024
    s_waitcnt vmcnt(9)
    v_mfma_f32_32x32x16_bf16 a[192:207], a[28:31], v[180:183], a[192:207]
    buffer_load_dwordx4 v[220:223], v2, s[40:43], s29 offen offset:1024 sc1
    ds_write_b128 v12, a[216:219] offset:2048
    v_mfma_f32_32x32x16_bf16 v[24:39], a[16:19], v[176:179], v[24:39]
    s_waitcnt vmcnt(9)
    v_mfma_f32_32x32x16_bf16 a[192:207], a[36:39], v[184:187], a[192:207]
    buffer_load_dwordx4 v[224:227], v2, s[40:43], s29 offen offset:2048 sc1
    ds_write_b128 v12, a[220:223] offset:3072
    s_waitcnt vmcnt(9)
    v_mfma_f32_32x32x16_bf16 a[192:207], a[44:47], v[188:191], a[192:207]
    buffer_load_dwordx4 v[228:231], v2, s[40:43], s29 offen offset:3072 sc1
    v_mfma_f32_32x32x16_bf16 v[24:39], a[24:27], v[180:183], v[24:39]
    ds_write_b128 v13, a[224:227] offset:0
    s_waitcnt vmcnt(9)
    v_mfma_f32_32x32x16_bf16 a[192:207], a[52:55], v[192:195], a[192:207]
    s_add_u32 s29, s29, 4096
    buffer_load_dwordx4 v[232:235], v2, s[40:43], s29 offen offset:0 sc1
    s_waitcnt vmcnt(9)
    v_mfma_f32_32x32x16_bf16 a[192:207], a[60:63], v[196:199], a[192:207]
    buffer_load_dwordx4 v[236:239], v2, s[40:43], s29 offen offset:1024 sc1
    ds_write_b128 v13, a[228:231] offset:1024
    v_mfma_f32_32x32x16_bf16 v[24:39], a[32:35], v[184:187], v[24:39]
    ds_write_b128 v13, a[232:235] offset:2048
    s_waitcnt vmcnt(9)
    v_mfma_f32_32x32x16_bf16 a[192:207], a[68:71], v[200:203], a[192:207]
    buffer_load_dwordx4 v[240:243], v2, s[40:43], s29 offen offset:2048 sc1
    v_mfma_f32_32x32x16_bf16 v[24:39], a[40:43], v[188:191], v[24:39]
    ds_write_b128 v13, a[236:239] offset:3072
    s_waitcnt vmcnt(9)
    v_mfma_f32_32x32x16_bf16 a[192:207], a[76:79], v[204:207], a[192:207]
    buffer_load_dwordx4 v[244:247], v2, s[40:43], s29 offen offset:3072 sc1
    s_waitcnt vmcnt(9)
    v_mfma_f32_32x32x16_bf16 a[192:207], a[84:87], v[208:211], a[192:207]
    s_add_u32 s29, s29, s30
    buffer_load_dwordx4 v[248:251], v2, s[40:43], s29 offen offset:0 sc1
    v_mfma_f32_32x32x16_bf16 v[24:39], a[48:51], v[192:195], v[24:39]
    s_waitcnt vmcnt(9)
    v_mfma_f32_32x32x16_bf16 a[192:207], a[92:95], v[212:215], a[192:207]
    buffer_load_dwordx4 v[252:255], v2, s[40:43], s29 offen offset:1024 sc1
    v_mfma_f32_32x32x16_bf16 v[24:39], a[56:59], v[196:199], v[24:39]
    s_waitcnt vmcnt(9)
    v_mfma_f32_32x32x16_bf16 a[192:207], a[100:103], v[216:219], a[192:207]
    s_waitcnt lgkmcnt(0)
    s_barrier
    s_waitcnt vmcnt(8)
    v_mfma_f32_32x32x16_bf16 a[192:207], a[108:111], v[220:223], a[192:207]
    ds_read_b128 v[112:115], v14 offset:4096
    v_mfma_f32_32x32x16_bf16 v[24:39], a[64:67], v[200:203], v[24:39]
    ds_read_b128 v[116:119], v14 offset:5120
    s_waitcnt vmcnt(7)
    v_mfma_f32_32x32x16_bf16 a[192:207], a[116:119], v[224:227], a[192:207]
    ds_read_b128 v[120:123], v14 offset:6144
    v_mfma_f32_32x32x16_bf16 v[24:39], a[72:75], v[204:207], v[24:39]
    ds_read_b128 v[124:127], v14 offset:7168
    s_waitcnt vmcnt(6)
    v_mfma_f32_32x32x16_bf16 a[192:207], a[124:127], v[228:231], a[192:207]
    ds_read_b128 v[128:131], v14 offset:8192
    s_waitcnt vmcnt(5)
    v_mfma_f32_32x32x16_bf16 a[192:207], a[132:135], v[232:235], a[192:207]
    ds_read_b128 v[132:135], v14 offset:9216
    v_mfma_f32_32x32x16_bf16 v[24:39], a[80:83], v[208:211], v[24:39]
    ds_read_b128 v[136:139], v14 offset:10240
    s_waitcnt vmcnt(4)
    v_mfma_f32_32x32x16_bf16 a[192:207], a[140:143], v[236:239], a[192:207]
    ds_read_b128 v[140:143], v14 offset:11264
    s_waitcnt lgkmcnt(7)
    v_fma_f32 v40, v112, v64, v40
    v_fma_f32 v41, v113, v65, v41
    v_fma_f32 v42, v114, v66, v42
    v_fma_f32 v43, v115, v67, v43
    s_waitcnt lgkmcnt(6)
    v_fma_f32 v44, v116, v68, v44
    v_fma_f32 v45, v117, v69, v45
    s_waitcnt vmcnt(3)
    v_mfma_f32_32x32x16_bf16 a[192:207], a[148:151], v[240:243], a[192:207]
    v_fma_f32 v46, v118, v70, v46
    v_fma_f32 v47, v119, v71, v47
    s_waitcnt lgkmcnt(5)
    v_fma_f32 v48, v120, v72, v48
    v_fma_f32 v49, v121, v73, v49
    v_fma_f32 v50, v122, v74, v50
    v_fma_f32 v51, v123, v75, v51
    v_mfma_f32_32x32x16_bf16 v[24:39], a[88:91], v[212:215], v[24:39]
    s_waitcnt lgkmcnt(4)
    v_fma_f32 v52, v124, v76, v52
    v_fma_f32 v53, v125, v77, v53
    v_fma_f32 v54, v126, v78, v54
    v_fma_f32 v55, v127, v79, v55
    s_waitcnt lgkmcnt(3)
    v_fma_f32 v40, v128, v64, v40
    v_fma_f32 v41, v129, v65, v41
    s_waitcnt vmcnt(2)
    v_mfma_f32_32x32x16_bf16 a[192:207], a[156:159], v[244:247], a[192:207]
    v_fma_f32 v42, v130, v66, v42
    v_fma_f32 v43, v131, v67, v43
    s_waitcnt lgkmcnt(2)
    v_fma_f32 v44, v132, v68, v44
    v_fma_f32 v45, v133, v69, v45
    v_fma_f32 v46, v134, v70, v46
    v_fma_f32 v47, v135, v71, v47
    v_mfma_f32_32x32x16_bf16 v[24:39], a[96:99], v[216:219], v[24:39]
    s_waitcnt lgkmcnt(1)
    v_fma_f32 v48, v136, v72, v48
    v_fma_f32 v49, v137, v73, v49
    v_fma_f32 v50, v138, v74, v50
    v_fma_f32 v51, v139, v75, v51
    s_waitcnt lgkmcnt(0)
    v_fma_f32 v52, v140, v76, v52
    v_fma_f32 v53, v141, v77, v53
    s_waitcnt vmcnt(1)
    v_mfma_f32_32x32x16_bf16 a[192:207], a[164:167], v[248:251], a[192:207]
    v_fma_f32 v54, v142, v78, v54
    v_fma_f32 v55, v143, v79, v55
    s_waitcnt vmcnt(0)
    v_mfma_f32_32x32x16_bf16 a[192:207], a[172:175], v[252:255], a[192:207]
    v_mfma_f32_32x32x16_bf16 v[24:39], a[104:107], v[220:223], v[24:39]
    v_mfma_f32_32x32x16_bf16 v[24:39], a[112:115], v[224:227], v[24:39]
    s_nop 9
    ds_write_b128 v11, a[192:195] offset:0
    ds_write_b128 v11, a[196:199] offset:1024
    ds_write_b128 v11, a[200:203] offset:2048
    ds_write_b128 v11, a[204:207] offset:3072
    v_mfma_f32_32x32x16_bf16 v[24:39], a[120:123], v[228:231], v[24:39]
    v_mfma_f32_32x32x16_bf16 v[24:39], a[128:131], v[232:235], v[24:39]
    s_waitcnt lgkmcnt(0)
    s_barrier
    ds_read_b128 v[96:99], v14 offset:0
    ds_read_b128 v[100:103], v14 offset:1024
    ds_read_b128 v[104:107], v14 offset:2048
    ds_read_b128 v[108:111], v14 offset:3072
    v_mfma_f32_32x32x16_bf16 v[24:39], a[136:139], v[236:239], v[24:39]
    v_mfma_f32_32x32x16_bf16 v[24:39], a[144:147], v[240:243], v[24:39]
    v_mfma_f32_32x32x16_bf16 v[24:39], a[152:155], v[244:247], v[24:39]
    v_mfma_f32_32x32x16_bf16 v[24:39], a[160:163], v[248:251], v[24:39]
    v_mfma_f32_32x32x16_bf16 v[24:39], a[168:171], v[252:255], v[24:39]
    s_waitcnt lgkmcnt(3)
    v_fma_f32 v40, v96, v64, v40
    v_fma_f32 v41, v97, v65, v41
    v_fma_f32 v42, v98, v66, v42
    v_fma_f32 v43, v99, v67, v43
    s_waitcnt lgkmcnt(2)
    v_fma_f32 v44, v100, v68, v44
    v_fma_f32 v45, v101, v69, v45
    v_fma_f32 v46, v102, v70, v46
    v_fma_f32 v47, v103, v71, v47
    s_waitcnt lgkmcnt(1)
    v_fma_f32 v48, v104, v72, v48
    v_fma_f32 v49, v105, v73, v49
    v_fma_f32 v50, v106, v74, v50
    v_fma_f32 v51, v107, v75, v51
    s_waitcnt lgkmcnt(0)
    v_fma_f32 v52, v108, v76, v52
    v_fma_f32 v53, v109, v77, v53
    v_fma_f32 v54, v110, v78, v54
    v_fma_f32 v55, v111, v79, v55
    v_pk_fma_f32 v[24:25], v[24:25], v[64:65], v[40:41]
    v_pk_fma_f32 v[26:27], v[26:27], v[66:67], v[42:43]
    v_cvt_pk_bf16_f32 v80, v24, v25
    v_cvt_pk_bf16_f32 v81, v26, v27
    ds_write_b64 v17, v[80:81] offset:0
    v_pk_fma_f32 v[28:29], v[28:29], v[68:69], v[44:45]
    v_pk_fma_f32 v[30:31], v[30:31], v[70:71], v[46:47]
    v_cvt_pk_bf16_f32 v82, v28, v29
    v_cvt_pk_bf16_f32 v83, v30, v31
    ds_write_b64 v17, v[82:83] offset:16
    v_pk_fma_f32 v[32:33], v[32:33], v[72:73], v[48:49]
    v_pk_fma_f32 v[34:35], v[34:35], v[74:75], v[50:51]
    v_cvt_pk_bf16_f32 v84, v32, v33
    v_cvt_pk_bf16_f32 v85, v34, v35
    ds_write_b64 v17, v[84:85] offset:32
    v_pk_fma_f32 v[36:37], v[36:37], v[76:77], v[52:53]
    v_pk_fma_f32 v[38:39], v[38:39], v[78:79], v[54:55]
    v_cvt_pk_bf16_f32 v86, v36, v37
    v_cvt_pk_bf16_f32 v87, v38, v39
    ds_write_b64 v17, v[86:87] offset:48
    ds_read_b128 v[88:91], v18 offset:0
    ds_read_b128 v[92:95], v18 offset:1280
    s_waitcnt lgkmcnt(1)
    buffer_store_dwordx4 v[88:91], v15, s[36:39], s74 offen
    s_waitcnt lgkmcnt(0)
    buffer_store_dwordx4 v[92:95], v16, s[36:39], s74 offen
L_end:
    s_endpgm
L_slow_3:
    v_pk_fma_f32 v[106:107], v[106:107], v[174:175], v[170:171]
    v_pk_fma_f32 v[108:109], v[108:109], v[176:177], v[172:173]
    v_cvt_pk_bf16_f32 v96, v106, v107
    v_cvt_pk_bf16_f32 v97, v108, v109
    v_min_u32 v96, -2, v96
    buffer_store_dwordx2 v[96:97], v152, s[40:43], s34 offen sc1
    v_pk_fma_f32 v[110:111], v[110:111], v[174:175], v[170:171]
    v_pk_fma_f32 v[112:113], v[112:113], v[176:177], v[172:173]
    v_cvt_pk_bf16_f32 v98, v110, v111
    v_cvt_pk_bf16_f32 v99, v112, v113
    v_min_u32 v98, -2, v98
    buffer_store_dwordx2 v[98:99], v153, s[40:43], s34 offen sc1
    v_pk_fma_f32 v[114:115], v[114:115], v[174:175], v[170:171]
    v_pk_fma_f32 v[116:117], v[116:117], v[176:177], v[172:173]
    v_cvt_pk_bf16_f32 v100, v114, v115
    v_cvt_pk_bf16_f32 v101, v116, v117
    v_min_u32 v100, -2, v100
    buffer_store_dwordx2 v[100:101], v154, s[40:43], s34 offen sc1
    v_pk_fma_f32 v[118:119], v[118:119], v[174:175], v[170:171]
    v_pk_fma_f32 v[120:121], v[120:121], v[176:177], v[172:173]
    v_cvt_pk_bf16_f32 v102, v118, v119
    v_cvt_pk_bf16_f32 v103, v120, v121
    v_min_u32 v102, -2, v102
    buffer_store_dwordx2 v[102:103], v155, s[40:43], s34 offen sc1
    v_pk_fma_f32 v[122:123], v[122:123], v[174:175], v[170:171]
    v_pk_fma_f32 v[124:125], v[124:125], v[176:177], v[172:173]
    v_cvt_pk_bf16_f32 v104, v122, v123
    v_cvt_pk_bf16_f32 v105, v124, v125
    v_min_u32 v104, -2, v104
    buffer_store_dwordx2 v[104:105], v156, s[40:43], s34 offen sc1
    s_waitcnt vmcnt(0)
    buffer_store_dwordx2 v[8:9], v6, s[40:43], 0 offen offset:2048 sc1
    buffer_load_dwordx2 v[4:5], v3, s[40:43], 0 offen offset:2048 sc1
    s_mov_b32 s66, 0x4e20
    s_waitcnt vmcnt(0)
L_chk_33:
    v_cmp_ne_u64 vcc, s[44:45], v[4:5]
    s_and_b64 vcc, vcc, s[82:83]
    s_cbranch_scc0 L_ok_34
    s_sub_u32 s66, s66, 1
    s_cbranch_scc1 L_ok_34
    buffer_load_dwordx2 v[4:5], v3, s[40:43], 0 offen offset:2048 sc1
    s_waitcnt vmcnt(0)
    s_branch L_chk_33
L_ok_34:
    s_waitcnt vmcnt(0)
    s_branch L_join_4
L_again_7:
    s_nop 7
    s_mov_b32 s6, m0
    s_mov_b32 s7, s67
    s_mov_b32 s66, 0x4e20
L_agl_35:
    s_add_u32 m0, s33, 0
    s_add_u32 s67, s32, 0
    buffer_load_dwordx4 v2, s[40:43], s67 offen offset:0 sc1 lds
    buffer_load_dwordx4 v2, s[40:43], s67 offen offset:1024 sc1 lds
    buffer_load_dwordx4 v2, s[40:43], s67 offen offset:2048 sc1 lds
    buffer_load_dwordx4 v2, s[40:43], s67 offen offset:3072 sc1 lds
    s_add_u32 m0, s33, 4096
    s_add_u32 s67, s32, 4096
    buffer_load_dwordx4 v2, s[40:43], s67 offen offset:0 sc1 lds
    s_sub_u32 s66, s66, 1
    s_cbranch_scc1 L_agx_36
    s_waitcnt vmcnt(0)
    ds_read_b128 v[160:163], v159 offset:0
    ds_read_b128 v[164:167], v159 offset:1024
    ds_read_b128 v[168:171], v159 offset:2048
    ds_read_b128 v[172:175], v159 offset:3072
    ds_read_b128 v[176:179], v159 offset:4096
    s_waitcnt lgkmcnt(3)
    v_max3_u32 v161, v160, v162, v164
    s_waitcnt lgkmcnt(2)
    v_max3_u32 v161, v161, v166, v168
    s_waitcnt lgkmcnt(1)
    v_max3_u32 v161, v161, v170, v172
    s_waitcnt lgkmcnt(0)
    v_max3_u32 v161, v161, v174, v176
    v_max_u32 v161, v161, v178
    v_cmp_eq_u32 vcc, -1, v161
    s_cmp_lg_u64 vcc, 0
    s_nop 2
    s_cbranch_scc1 L_agl_35
L_agx_36:
    s_waitcnt vmcnt(0)
    s_mov_b32 m0, s6
    s_mov_b32 s67, s7
    s_branch L_hok_8
L_again_9:
    s_nop 7
    s_mov_b32 s6, m0
    s_mov_b32 s7, s67
    s_mov_b32 s66, 0x4e20
L_agl_37:
    s_add_u32 m0, s33, 20480
    s_add_u32 s67, s32, 20480
    buffer_load_dwordx4 v2, s[40:43], s67 offen offset:0 sc1 lds
    buffer_load_dwordx4 v2, s[40:43], s67 offen offset:1024 sc1 lds
    buffer_load_dwordx4 v2, s[40:43], s67 offen offset:2048 sc1 lds
    buffer_load_dwordx4 v2, s[40:43], s67 offen offset:3072 sc1 lds
    s_add_u32 m0, s33, 24576
    s_add_u32 s67, s32, 24576
    buffer_load_dwordx4 v2, s[40:43], s67 offen offset:0 sc1 lds
    s_sub_u32 s66, s66, 1
    s_cbranch_scc1 L_agx_38
    s_waitcnt vmcnt(0)
    ds_read_b128 v[160:163], v159 offset:20480
    ds_read_b128 v[164:167], v159 offset:21504
    ds_read_b128 v[168:171], v159 offset:22528
    ds_read_b128 v[172:175], v159 offset:23552
    ds_read_b128 v[176:179], v159 offset:24576
    s_waitcnt lgkmcnt(3)
    v_max3_u32 v161, v160, v162, v164
    s_waitcnt lgkmcnt(2)
    v_max3_u32 v161, v161, v166, v168
    s_waitcnt lgkmcnt(1)
    v_max3_u32 v161, v161, v170, v172
    s_waitcnt lgkmcnt(0)
    v_max3_u32 v161, v161, v174, v176
    v_max_u32 v161, v161, v178
    v_cmp_eq_u32 vcc, -1, v161
    s_cmp_lg_u64 vcc, 0
    s_nop 2
    s_cbranch_scc1 L_agl_37
L_agx_38:
    s_waitcnt vmcnt(0)
    s_mov_b32 m0, s6
    s_mov_b32 s67, s7
    s_branch L_hok_10
L_again_11:
    s_nop 7
    s_mov_b32 s6, m0
    s_mov_b32 s7, s67
    s_mov_b32 s66, 0x4e20
L_agl_39:
    s_add_u32 m0, s33, 40960
    s_add_u32 s67, s32, 88064
    buffer_load_dwordx4 v2, s[40:43], s67 offen offset:0 sc1 lds
    buffer_load_dwordx4 v2, s[40:43], s67 offen offset:1024 sc1 lds
    buffer_load_dwordx4 v2, s[40:43], s67 offen offset:2048 sc1 lds
    buffer_load_dwordx4 v2, s[40:43], s67 offen offset:3072 sc1 lds
    s_add_u32 m0, s33, 45056
    s_add_u32 s67, s32, 92160
    buffer_load_dwordx4 v2, s[40:43], s67 offen offset:0 sc1 lds
    s_sub_u32 s66, s66, 1
    s_cbranch_scc1 L_agx_40
    s_waitcnt vmcnt(0)
    ds_read_b128 v[160:163], v159 offset:0
    ds_read_b128 v[164:167], v159 offset:1024
    ds_read_b128 v[168:171], v159 offset:2048
    ds_read_b128 v[172:175], v159 offset:3072
    ds_read_b128 v[176:179], v159 offset:4096
    s_waitcnt lgkmcnt(3)
    v_max3_u32 v161, v160, v162, v164
    s_waitcnt lgkmcnt(2)
    v_max3_u32 v161, v161, v166, v168
    s_waitcnt lgkmcnt(1)
    v_max3_u32 v161, v161, v170, v172
    s_waitcnt lgkmcnt(0)
    v_max3_u32 v161, v161, v174, v176
    v_max_u32 v161, v161, v178
    v_cmp_eq_u32 vcc, -1, v161
    s_cmp_lg_u64 vcc, 0
    s_nop 2
    s_cbranch_scc1 L_agl_39
L_agx_40:
    s_waitcnt vmcnt(0)
    s_mov_b32 m0, s6
    s_mov_b32 s67, s7
    s_branch L_hok_12
L_again_15:
    s_nop 7
    s_mov_b32 s6, m0
    s_mov_b32 s7, s67
    s_mov_b32 s66, 0x4e20
L_agl_41:
    s_add_u32 m0, s33, 61440
    s_add_u32 s67, s32, 108544
    buffer_load_dwordx4 v2, s[40:43], s67 offen offset:0 sc1 lds
    buffer_load_dwordx4 v2, s[40:43], s67 offen offset:1024 sc1 lds
    buffer_load_dwordx4 v2, s[40:43], s67 offen offset:2048 sc1 lds
    buffer_load_dwordx4 v2, s[40:43], s67 offen offset:3072 sc1 lds
    s_add_u32 m0, s33, 65536
    s_add_u32 s67, s32, 112640
    buffer_load_dwordx4 v2, s[40:43], s67 offen offset:0 sc1 lds
    s_sub_u32 s66, s66, 1
    s_cbranch_scc1 L_agx_42
    s_waitcnt vmcnt(0)
    ds_read_b128 v[160:163], v159 offset:20480
    ds_read_b128 v[164:167], v159 offset:21504
    ds_read_b128 v[168:171], v159 offset:22528
    ds_read_b128 v[172:175], v159 offset:23552
    ds_read_b128 v[176:179], v159 offset:24576
    s_waitcnt lgkmcnt(3)
    v_max3_u32 v161, v160, v162, v164
    s_waitcnt lgkmcnt(2)
    v_max3_u32 v161, v161, v166, v168
    s_waitcnt lgkmcnt(1)
    v_max3_u32 v161, v161, v170, v172
    s_waitcnt lgkmcnt(0)
    v_max3_u32 v161, v161, v174, v176
    v_max_u32 v161, v161, v178
    v_cmp_eq_u32 vcc, -1, v161
    s_cmp_lg_u64 vcc, 0
    s_nop 2
    s_cbranch_scc1 L_agl_41
L_agx_42:
    s_waitcnt vmcnt(0)
    s_mov_b32 m0, s6
    s_mov_b32 s67, s7
    s_branch L_hok_16
L_slow_17:
    s_nop 7
    buffer_store_dwordx4 v[208:211], v7, s[40:43], 0 offen sc1
    buffer_store_dwordx4 v[212:215], v7, s[40:43], s71 offen sc1
    s_waitcnt vmcnt(0)
    buffer_store_dwordx2 v[8:9], v6, s[40:43], 0 offen offset:0 sc1
    s_branch L_join_18
L_slow_23:
    s_nop 7
    buffer_store_dwordx4 v[112:115], v250, s[36:39], s74 offen offset:0 sc1
    buffer_store_dwordx4 v[116:119], v250, s[36:39], s74 offen offset:2048 sc1
    buffer_store_dword v120, v251, s[40:43], s75 offen sc1
    s_waitcnt vmcnt(0)
    buffer_store_dwordx2 v[8:9], v6, s[40:43], 0 offen offset:2560 sc1
    s_branch L_join_24
L_redo:
    s_waitcnt vmcnt(0)
    s_waitcnt lgkmcnt(0)
    s_nop 15
    s_nop 15
    s_sub_u32 s57, s35, 28672
    v_mov_b32 v12, v14
    s_mov_b32 s66, 0x4e20
    s_mov_b32 s58, 0x10
    v_mov_b32 v40, 0
    v_mov_b32 v41, 0
    v_mov_b32 v42, 0
    v_mov_b32 v43, 0
    v_mov_b32 v44, 0
    v_mov_b32 v45, 0
    v_mov_b32 v46, 0
    v_mov_b32 v47, 0
    v_mov_b32 v48, 0
    v_mov_b32 v49, 0
    v_mov_b32 v50, 0
    v_mov_b32 v51, 0
    v_mov_b32 v52, 0
    v_mov_b32 v53, 0
    v_mov_b32 v54, 0
    v_mov_b32 v55, 0
    v_mov_b32 v56, 0
    v_mov_b32 v57, 0
    v_mov_b32 v58, 0
    v_mov_b32 v59, 0
    v_mov_b32 v60, 0
    v_mov_b32 v61, 0
    v_mov_b32 v62, 0
    v_mov_b32 v63, 0
    v_mov_b32 v64, 0
    v_mov_b32 v65, 0
    v_mov_b32 v66, 0
    v_mov_b32 v67, 0
    v_mov_b32 v68, 0
    v_mov_b32 v69, 0
    v_mov_b32 v70, 0
    v_mov_b32 v71, 0
    v_mov_b32 v72, 0
    v_mov_b32 v73, 0
    v_mov_b32 v74, 0
    v_mov_b32 v75, 0
    v_mov_b32 v76, 0
    v_mov_b32 v77, 0
    v_mov_b32 v78, 0
    v_mov_b32 v79, 0
    v_mov_b32 v80, 0
    v_mov_b32 v81, 0
    v_mov_b32 v82, 0
    v_mov_b32 v83, 0
    v_mov_b32 v84, 0
    v_mov_b32 v85, 0
    v_mov_b32 v86, 0
    v_mov_b32 v87, 0
L_redo1:
    buffer_load_dwordx4 v[128:131], v2, s[36:39], s57 offen offset:0 sc1
    buffer_load_dwordx4 v[132:135], v2, s[36:39], s57 offen offset:1024 sc1
    ds_read_b64_tr_b16 v[88:89], v12 offset:0
    ds_read_b64_tr_b16 v[90:91], v12 offset:3072
    ds_read_b64_tr_b16 v[92:93], v12 offset:64
    ds_read_b64_tr_b16 v[94:95], v12 offset:3136
    ds_read_b64_tr_b16 v[96:97], v12 offset:128
    ds_read_b64_tr_b16 v[98:99], v12 offset:3200
    ds_read_b64_tr_b16 v[100:101], v12 offset:1536
    ds_read_b64_tr_b16 v[102:103], v12 offset:4608
    ds_read_b64_tr_b16 v[104:105], v12 offset:1600
    ds_read_b64_tr_b16 v[106:107], v12 offset:4672
    ds_read_b64_tr_b16 v[108:109], v12 offset:1664
    ds_read_b64_tr_b16 v[110:111], v12 offset:4736
    s_waitcnt vmcnt(0)
    v_max_u32 v124, v128, v132
    s_sub_u32 s66, s66, 1
    s_cselect_b32 s59, 0, -1
    v_cmp_eq_u32 vcc, s59, v124
    s_max_i32 s66, s66, 0
    s_waitcnt lgkmcnt(0)
    s_cmp_lg_u32 s59, 0
    s_cselect_b64 vcc, vcc, 0
    s_cmp_lg_u64 vcc, 0
    s_cbranch_scc1 L_redo1
    v_mfma_f32_32x32x16_bf16 v[40:55], v[88:91], v[128:131], v[40:55]
    v_mfma_f32_32x32x16_bf16 v[56:71], v[92:95], v[128:131], v[56:71]
    v_mfma_f32_32x32x16_bf16 v[72:87], v[96:99], v[128:131], v[72:87]
    v_mfma_f32_32x32x16_bf16 v[40:55], v[100:103], v[132:135], v[40:55]
    v_mfma_f32_32x32x16_bf16 v[56:71], v[104:107], v[132:135], v[56:71]
    v_mfma_f32_32x32x16_bf16 v[72:87], v[108:111], v[132:135], v[72:87]
    v_add_u32 v12, 6144, v12
    s_add_u32 s57, s57, 2048
    s_sub_u32 s58, s58, 1
    s_cmp_lg_u32 s58, 0
    s_nop 6
    s_cbranch_scc1 L_redo1
    v_mfma_f32_32x32x8_bf16 v[40:55], v[112:113], v[118:119], v[40:55]
    v_mfma_f32_32x32x8_bf16 v[56:71], v[114:115], v[118:119], v[56:71]
    v_mfma_f32_32x32x8_bf16 v[72:87], v[116:117], v[118:119], v[72:87]
    s_nop 9
    v_cvt_pk_bf16_f32 v128, v40, v41
    v_cvt_pk_bf16_f32 v129, v42, v43
    v_cvt_pk_bf16_f32 v130, v44, v45
    v_cvt_pk_bf16_f32 v131, v46, v47
    v_pk_max_i16 v128, v128, 0
    v_pk_max_i16 v129, v129, 0
    v_pk_max_i16 v130, v130, 0
    v_pk_max_i16 v131, v131, 0
    buffer_store_dwordx4 v[128:131], v2, s[40:43], s32 offen offset:0 sc1
    v_cvt_pk_bf16_f32 v132, v48, v49
    v_cvt_pk_bf16_f32 v133, v50, v51
    v_cvt_pk_bf16_f32 v134, v52, v53
    v_cvt_pk_bf16_f32 v135, v54, v55
    v_pk_max_i16 v132, v132, 0
    v_pk_max_i16 v133, v133, 0
    v_pk_max_i16 v134, v134, 0
    v_pk_max_i16 v135, v135, 0
    buffer_store_dwordx4 v[132:135], v2, s[40:43], s32 offen offset:1024 sc1
    v_cvt_pk_bf16_f32 v136, v56, v57
    v_cvt_pk_bf16_f32 v137, v58, v59
    v_cvt_pk_bf16_f32 v138, v60, v61
    v_cvt_pk_bf16_f32 v139, v62, v63
    v_pk_max_i16 v136, v136, 0
    v_pk_max_i16 v137, v137, 0
    v_pk_max_i16 v138, v138, 0
    v_pk_max_i16 v139, v139, 0
    buffer_store_dwordx4 v[136:139], v2, s[40:43], s33 offen offset:0 sc1
    v_cvt_pk_bf16_f32 v140, v64, v65
    v_cvt_pk_bf16_f32 v141, v66, v67
    v_cvt_pk_bf16_f32 v142, v68, v69
    v_cvt_pk_bf16_f32 v143, v70, v71
    v_pk_max_i16 v140, v140, 0
    v_pk_max_i16 v141, v141, 0
    v_pk_max_i16 v142, v142, 0
    v_pk_max_i16 v143, v143, 0
    buffer_store_dwordx4 v[140:143], v2, s[40:43], s33 offen offset:1024 sc1
    v_cvt_pk_bf16_f32 v144, v72, v73
    v_cvt_pk_bf16_f32 v145, v74, v75
    v_cvt_pk_bf16_f32 v146, v76, v77
    v_cvt_pk_bf16_f32 v147, v78, v79
    v_pk_max_i16 v144, v144, 0
    v_pk_max_i16 v145, v145, 0
    v_pk_max_i16 v146, v146, 0
    v_pk_max_i16 v147, v147, 0
    buffer_store_dwordx4 v[144:147], v2, s[40:43], s34 offen offset:0 sc1
    v_cvt_pk_bf16_f32 v148, v80, v81
    v_cvt_pk_bf16_f32 v149, v82, v83
    v_cvt_pk_bf16_f32 v150, v84, v85
    v_cvt_pk_bf16_f32 v151, v86, v87
    v_pk_max_i16 v148, v148, 0
    v_pk_max_i16 v149, v149, 0
    v_pk_max_i16 v150, v150, 0
    v_pk_max_i16 v151, v151, 0
    buffer_store_dwordx4 v[148:151], v2, s[40:43], s34 offen offset:1024 sc1
    s_waitcnt vmcnt(0)
    s_branch L_dj
L_slow_29:
    s_nop 7
    buffer_store_dwordx4 v[128:131], v2, s[40:43], s32 offen offset:0 sc1
    buffer_store_dwordx4 v[132:135], v2, s[40:43], s32 offen offset:1024 sc1
    buffer_store_dwordx4 v[136:139], v2, s[40:43], s33 offen offset:0 sc1
    buffer_store_dwordx4 v[140:143], v2, s[40:43], s33 offen offset:1024 sc1
    buffer_store_dwordx4 v[144:147], v2, s[40:43], s34 offen offset:0 sc1
    buffer_store_dwordx4 v[148:151], v2, s[40:43], s34 offen offset:1024 sc1
    s_waitcnt vmcnt(0)
    buffer_store_dwordx2 v[8:9], v6, s[40:43], 0 offen offset:1024 sc1
    s_branch L_join_30
.fill 933, 4, 0xbf810000
.section .rodata,"a"
.p2align 6
.amdhsa_kernel adaLN_cond__sliding_local_dilated__dense_activation_relu__prompt_kernel
  .amdhsa_next_free_vgpr 512
  .amdhsa_next_free_sgpr 102
  .amdhsa_accum_offset 256
  .amdhsa_group_segment_fixed_size 0
  .amdhsa_kernarg_size 88
  .amdhsa_user_sgpr_count 2
  .amdhsa_user_sgpr_kernarg_segment_ptr 1
  .amdhsa_system_sgpr_workgroup_id_x 1
.end_amdhsa_kernel
```
